```python
import torch

def _softmax(x, axis=-1):
    return torch.softmax(x, dim=axis)
def _gelu(x):
    return torch.nn.functional.gelu(x, approximate="tanh")
def _silu(x):
    return torch.nn.functional.silu(x)
def _sigmoid(x):
    return torch.sigmoid(x)
def _layernorm(x, axis=-1, eps=1e-5):
    m = x.mean(dim=axis, keepdim=True)
    v = x.var(dim=axis, keepdim=True, unbiased=False)
    return (x - m) / torch.sqrt(v + eps)
def _scatter_add(tgt, idx, src, axis=0):
    return tgt.clone().index_add_(axis, idx, src)
def _segment_sum(src, seg, n):
    out = torch.zeros((n,) + src.shape[1:], dtype=src.dtype)
    return out.index_add_(0, seg, src)
def _pad(x, pw):
    flat = tuple(v for pair in reversed(pw) for v in pair)
    return torch.nn.functional.pad(x, flat)

kernel_name = 'gated_mix__linear_kernel_hedgehog__softmax_full_mha__prompt'

def setup_inputs():

    _w = (lambda a: (lambda t: t.to(torch.bfloat16) if t.is_floating_point() else t)(torch.as_tensor(a)))
    def _A_setup():
        B, S, D, H = 1, 2048, 1024, 32
        Dh = D // H
        return {
            "x": _w((lambda *s: torch.randn(*s, dtype=torch.bfloat16) * 0.05)(B, S, D)),
            "wqkv": _w((lambda *s: torch.randn(*s, dtype=torch.bfloat16) * 3.2)(D, 3 * D)),
            "w_phi": _w((lambda *s: torch.randn(*s, dtype=torch.bfloat16) * 3.2)(H, Dh, Dh) * (Dh ** -0.5)),
            "wo": _w((lambda *s: torch.randn(*s, dtype=torch.bfloat16) * 1.6)(D, D)),
        }
    _A_in = _A_setup()

    def _B_setup():
        B, S, D = 1, 2048, 1024
        return {
            "x": _w((lambda *s: torch.randn(*s, dtype=torch.bfloat16) * 0.05)(B, S, D)),
            "wqkv": _w((lambda *s: torch.randn(*s, dtype=torch.bfloat16) * 3.2)(D, 3 * D)),
            "wo": _w((lambda *s: torch.randn(*s, dtype=torch.bfloat16) * 0.1)(D, D)),
        }
    _B_in = _B_setup()

    return {
        "A_x": _A_in["x"],
        "A_wqkv": _A_in["wqkv"],
        "A_w_phi": _A_in["w_phi"],
        "A_wo": _A_in["wo"],
        "B_x": _B_in["x"],
        "B_wqkv": _B_in["wqkv"],
        "B_wo": _B_in["wo"],
        "gate_w": _w((lambda *s: torch.randn(*s, dtype=torch.bfloat16) * 0.4)(1024) * 16.0),
    }

def reference(A_x, A_wqkv, A_w_phi, A_wo, B_x, B_wqkv, B_wo, gate_w):
    def _A_ref(x, wqkv, w_phi, wo):
        B, S, D = x.shape
        H = 32; Dh = D // H
        qkv = (lambda x, *d: x.permute(*d))((x @ wqkv).reshape(B, S, 3, H, Dh), 2, 0, 3, 1, 4)
        q, k, v = qkv[0], qkv[1], qkv[2]
        pq = torch.einsum("bhsd,hdf->bhsf", q, w_phi)
        pk = torch.einsum("bhsd,hdf->bhsf", k, w_phi)
        phi_q = torch.concatenate([_softmax(pq, axis=-1), _softmax(-pq, axis=-1)], axis=-1)
        phi_k = torch.concatenate([_softmax(pk, axis=-1), _softmax(-pk, axis=-1)], axis=-1)
        kv = torch.einsum("bhsf,bhsd->bhfd", phi_k, v)
        z  = torch.einsum("bhsf->bhf", phi_k)
        num = torch.einsum("bhqf,bhfd->bhqd", phi_q, kv)
        den = torch.einsum("bhqf,bhf->bhq", phi_q, z)[..., None] + 1e-6
        o = num / den
        return (lambda x, *d: x.permute(*d))(o, 0, 2, 1, 3).reshape(B, S, D) @ wo

    def _B_ref(x, wqkv, wo):
        B, S, D = x.shape
        H = 32; Dh = D // H
        qkv = (lambda x, *d: x.permute(*d))((x @ wqkv).reshape(B, S, 3, H, Dh), 2, 0, 3, 1, 4)
        q, k, v = qkv[0], qkv[1], qkv[2]
        scale = Dh ** -0.5
        scores = torch.einsum("bhqd,bhkd->bhqk", q, k) * scale
        p = _softmax(scores, axis=-1)
        o = torch.einsum("bhqk,bhkd->bhqd", p, v)
        return (lambda x, *d: x.permute(*d))(o, 0, 2, 1, 3).reshape(B, S, D) @ wo

    x = A_x
    g = _sigmoid((x * gate_w).sum(-1, keepdims=True))
    a = _A_ref(x, A_wqkv, A_w_phi, A_wo)
    b = _B_ref(x, B_wqkv, B_wo)
    return g * a + (1 - g) * b
```

```asm
; @launch grid=(256,1,1) block=(512,1,1) lds=163840
.amdgcn_target "amdgcn-amd-amdhsa--gfx950"
.text
.p2alignl 12, 0xbf810000
.fill 832, 4, 0xbf810000
.globl gated_mix__linear_kernel_hedgehog__softmax_full_mha__prompt_kernel
.p2align 8
.type gated_mix__linear_kernel_hedgehog__softmax_full_mha__prompt_kernel,@function
gated_mix__linear_kernel_hedgehog__softmax_full_mha__prompt_kernel:
s_cmp_ge_u32 s2, 256
s_cbranch_scc1 K2_end
s_load_dwordx8 s[36:43], s[0:1], 0
s_load_dwordx8 s[44:51], s[0:1], 32
s_load_dwordx4 s[96:99], s[0:1], 64
s_load_dwordx2 s[100:101], s[0:1], 80
s_getpc_b64 s[62:63]
K1_pc:
s_lshl_b32 s60, s2, 10
s_and_b32 s60, s60, 0x6000
v_and_b32 v248, -8, v0
v_lshl_add_u32 v248, v248, 4, s60
v_mov_b32 v249, s63
v_add_co_u32 v248, vcc, s62, v248
s_nop 1
v_addc_co_u32 v249, vcc, 0, v249, vcc
global_load_dword v250, v[248:249], off offset:468
s_and_b32 s3, s2, 7
s_lshr_b32 s91, s2, 3
s_lshl_b32 s22, s3, 2
s_and_b32 s34, s91, 3
s_add_u32 s22, s22, s34
s_lshl_b32 s35, s3, 2
s_lshr_b32 s22, 0x74632501, s35
s_and_b32 s22, s22, 7
s_lshl_b32 s22, s22, 2
s_add_u32 s22, s22, s34
s_lshr_b32 s57, 0x65723410, s35
s_and_b32 s57, s57, 7
s_lshl_b32 s57, s57, 2
s_add_u32 s57, s57, s34
s_lshr_b32 s21, s91, 2
v_lshrrev_b32 v1, 6, v0
v_and_b32 v185, 63, v0
v_readfirstlane_b32 s20, v1
v_lshrrev_b32 v2, 3, v185
v_and_b32 v3, 7, v185
v_lshrrev_b32 v4, 4, v185
v_and_b32 v5, 15, v185
s_and_b32 s24, s20, 3
s_lshr_b32 s23, s20, 2
s_and_b32 s66, s20, 1
s_bfe_u32 s67, s20, 0x10001
v_xor_b32 v6, v3, v4
v_lshlrev_b32 v6, 4, v6
v_lshl_add_u32 v176, v2, 11, v6
v_xor_b32 v6, 64, v6
v_lshl_add_u32 v6, v2, 11, v6
v_add_u32 v177, 16384, v6
v_add_u32 v178, 32768, v176
v_add_u32 v179, 49152, v6
v_lshrrev_b32 v6, 2, v185
v_mul_u32_u24 v6, 6144, v6
v_lshrrev_b32 v7, 1, v185
v_lshrrev_b32 v8, 5, v185
v_xor_b32 v7, v7, v8
v_and_b32 v7, 1, v7
v_lshlrev_b32 v7, 5, v7
v_and_b32 v8, 1, v185
v_lshlrev_b32 v8, 4, v8
v_add3_u32 v180, v6, v7, v8
v_lshrrev_b32 v6, 1, v5
v_xor_b32 v6, v6, v4
v_lshlrev_b32 v6, 4, v6
v_lshl_add_u32 v6, v5, 7, v6
s_lshl_b32 s34, s24, 13
v_add_u32 v214, s34, v6
v_lshrrev_b32 v6, 1, v4
v_mul_u32_u24 v6, 6144, v6
v_and_b32 v7, 1, v4
v_mul_u32_u24 v7, 544, v7
v_add_u32 v6, v6, v7
v_bfe_u32 v7, v185, 2, 2
v_lshl_add_u32 v6, v7, 6, v6
v_and_b32 v7, 3, v185
v_lshl_add_u32 v6, v7, 3, v6
s_mul_i32 s34, s23, 3072
s_add_u32 s34, s34, 98304
v_add_u32 v215, s34, v6
v_lshrrev_b32 v6, 1, v4
v_lshlrev_b32 v6, 10, v6
v_and_b32 v7, 1, v4
v_lshl_add_u32 v6, v7, 9, v6
v_lshl_add_u32 v186, v5, 4, v6
v_lshrrev_b32 v7, 2, v5
v_lshl_add_u32 v6, v7, 7, v6
v_and_b32 v7, 3, v5
v_lshl_add_u32 v187, v7, 4, v6
s_lshl_b32 s26, s21, 8
s_lshl_b32 s34, s20, 5
s_add_u32 s26, s26, s34
s_lshl_b32 s26, s26, 11
s_lshl_b32 s30, s20, 12
s_cmp_eq_u32 s23, 0
s_cselect_b32 s90, s57, s22
s_sub_u32 s91, s57, s22
s_mul_i32 s35, s66, 98304
s_lshl_b32 s34, s90, 6
s_add_u32 s35, s35, s34
s_lshl_b32 s34, s67, 12
s_add_u32 s27, s35, s34
s_add_u32 s29, s27, 393216
s_add_u32 s27, s27, 196608
s_mul_i32 s34, s67, 196608
s_add_u32 s28, s35, s34
s_add_u32 s28, s28, 198656
s_mul_i32 s35, s66, 6144
s_mul_i32 s34, s23, 3072
s_add_u32 s35, s35, s34
s_lshl_b32 s34, s67, 11
s_add_u32 s31, s35, s34
s_add_u32 s33, s31, 24576
s_add_u32 s31, s31, 12288
s_mul_i32 s34, s67, 12288
s_add_u32 s32, s35, s34
s_add_u32 s32, s32, 13312
s_mov_b32 s68, 0
s_mov_b32 s69, 0
s_waitcnt lgkmcnt(0)
s_cmp_eq_u32 s23, 0
s_mov_b32 s4, s36
s_mov_b32 s5, s37
s_mov_b32 s6, 4194304
s_mov_b32 s7, 0x20000
s_cselect_b32 s8, s38, s46
s_cselect_b32 s9, s39, s47
s_mov_b32 s10, 6291456
s_mov_b32 s11, 0x20000
s_mov_b32 s44, s48
s_mov_b32 s45, s49
s_mov_b32 s48, s50
s_mov_b32 s49, s51
s_mov_b32 s50, s100
s_mov_b32 s51, s101
s_cselect_b32 s16, s40, s48
s_cselect_b32 s17, s41, s49
s_cselect_b32 s18, 32, 1
s_lshl_b32 s18, s18, 11
s_mov_b32 s19, 0x20000
s_sub_u32 s35, s27, 196608
s_add_u32 m0, s31, 86016
s_nop 0
buffer_load_dwordx4 v180, s[8:11], s35 offen lds
s_bitcmp1_b32 s20, 1
s_cbranch_scc1 K1_pro0
s_sub_u32 s35, s28, 196608
s_add_u32 m0, s32, 86016
s_nop 0
buffer_load_dwordx4 v180, s[8:11], s35 offen lds
K1_pro0:
s_add_u32 m0, s30, 0
s_nop 0
buffer_load_dwordx4 v176, s[4:7], s26 offen lds
s_add_u32 m0, s30, 1024
s_nop 0
buffer_load_dwordx4 v177, s[4:7], s26 offen lds
s_add_u32 m0, s30, 2048
s_nop 0
buffer_load_dwordx4 v178, s[4:7], s26 offen lds
s_add_u32 m0, s30, 3072
s_nop 0
buffer_load_dwordx4 v179, s[4:7], s26 offen lds
s_add_u32 s26, s26, 128
s_add_u32 s30, s30, 32768
s_sub_u32 s34, s30, 98304
s_min_u32 s30, s30, s34
s_mov_b32 s12, s50
s_mov_b32 s13, s51
s_mov_b32 s14, 29360128
s_mov_b32 s15, 0x20000
s_mov_b32 s52, s98
s_mov_b32 s53, s99
s_mov_b32 s54, 256
s_mov_b32 s55, 0x20000
s_cmp_eq_u32 s2, 8
s_cselect_b32 s94, 1, 0
s_cbranch_scc0 K1_noclr
v_mov_b32 v244, 0
v_mov_b32 v245, 0
v_mov_b32 v246, 0
v_mov_b32 v247, 0
v_lshlrev_b32 v243, 4, v185
s_lshl_b32 s34, s20, 12
s_add_u32 s34, s34, 19664896
buffer_store_dwordx4 v[244:247], v243, s[12:15], s34 offen offset:0 sc1
buffer_store_dwordx4 v[244:247], v243, s[12:15], s34 offen offset:1024 sc1
buffer_store_dwordx4 v[244:247], v243, s[12:15], s34 offen offset:2048 sc1
buffer_store_dwordx4 v[244:247], v243, s[12:15], s34 offen offset:3072 sc1
s_lshl_b32 s34, s20, 8
s_add_u32 s34, s34, 19660800
v_min_u32 v243, 15, v185
v_lshlrev_b32 v243, 4, v243
buffer_store_dwordx4 v[244:247], v243, s[12:15], s34 offen sc1
K1_noclr:
s_mov_b32 s95, s90
s_lshl_b32 s56, s21, 5
s_add_u32 s56, s56, s22
s_lshl_b32 s56, s56, 2
s_add_u32 s56, s56, s24
s_lshl_b32 s56, s56, 1
s_add_u32 m0, s31, 98304
s_nop 0
buffer_load_dwordx4 v180, s[8:11], s27 offen lds
s_add_u32 s27, s27, 393216
s_add_u32 s31, s31, 24576
s_sub_u32 s34, s31, 61440
s_min_u32 s31, s31, s34
s_add_u32 m0, s32, 98304
s_nop 0
buffer_load_dwordx4 v180, s[8:11], s28 offen lds
s_add_u32 s28, s28, 393216
s_add_u32 s32, s32, 24576
s_sub_u32 s34, s32, 61440
s_min_u32 s32, s32, s34
s_barrier
s_add_u32 m0, s33, 98304
s_nop 0
buffer_load_dwordx4 v180, s[8:11], s29 offen lds
s_add_u32 s29, s29, 393216
s_add_u32 s33, s33, 24576
s_sub_u32 s34, s33, 61440
s_min_u32 s33, s33, s34
s_add_u32 m0, s30, 0
s_nop 0
buffer_load_dwordx4 v176, s[4:7], s26 offen lds
s_add_u32 m0, s30, 1024
s_nop 0
buffer_load_dwordx4 v177, s[4:7], s26 offen lds
s_add_u32 m0, s30, 2048
s_nop 0
buffer_load_dwordx4 v178, s[4:7], s26 offen lds
s_add_u32 m0, s30, 3072
s_nop 0
buffer_load_dwordx4 v179, s[4:7], s26 offen lds
s_add_u32 s26, s26, 128
s_add_u32 s30, s30, 32768
s_sub_u32 s34, s30, 98304
s_min_u32 s30, s30, s34
s_and_b32 s34, s90, 1
s_lshl_b32 s34, s34, 3
s_add_u32 s34, s34, s21
s_lshl_b32 s34, s34, 2
s_add_u32 s34, s34, s24
s_mul_i32 s64, s34, 6144
s_lshr_b32 s34, s90, 1
s_lshl_b32 s34, s34, 7
s_add_u32 s64, s64, s34
s_add_u32 s65, s64, 5898240
s_add_u32 s64, s64, 786432
v_min_u32 v212, 5, v185
v_and_b32 v213, 1, v212
v_lshrrev_b32 v212, 1, v212
v_lshlrev_b32 v212, 11, v212
v_lshl_add_u32 v212, v213, 6, v212
buffer_load_dword v213, v212, s[8:11], s64 offen
s_add_u32 s64, s64, 393216
s_min_u32 s64, s64, s65
v_mov_b32 v0, 0
v_mov_b32 v1, 0
v_mov_b32 v2, 0
v_mov_b32 v3, 0
v_mov_b32 v4, 0
v_mov_b32 v5, 0
v_mov_b32 v6, 0
v_mov_b32 v7, 0
v_mov_b32 v8, 0
v_mov_b32 v9, 0
v_mov_b32 v10, 0
v_mov_b32 v11, 0
v_mov_b32 v12, 0
v_mov_b32 v13, 0
v_mov_b32 v14, 0
v_mov_b32 v15, 0
v_mov_b32 v16, 0
v_mov_b32 v17, 0
v_mov_b32 v18, 0
v_mov_b32 v19, 0
v_mov_b32 v20, 0
v_mov_b32 v21, 0
v_mov_b32 v22, 0
v_mov_b32 v23, 0
v_mov_b32 v24, 0
v_mov_b32 v25, 0
v_mov_b32 v26, 0
v_mov_b32 v27, 0
v_mov_b32 v28, 0
v_mov_b32 v29, 0
v_mov_b32 v30, 0
v_mov_b32 v31, 0
v_mov_b32 v32, 0
v_mov_b32 v33, 0
v_mov_b32 v34, 0
v_mov_b32 v35, 0
v_mov_b32 v36, 0
v_mov_b32 v37, 0
v_mov_b32 v38, 0
v_mov_b32 v39, 0
v_mov_b32 v40, 0
v_mov_b32 v41, 0
v_mov_b32 v42, 0
v_mov_b32 v43, 0
v_mov_b32 v44, 0
v_mov_b32 v45, 0
v_mov_b32 v46, 0
v_mov_b32 v47, 0
v_mov_b32 v48, 0
v_mov_b32 v49, 0
v_mov_b32 v50, 0
v_mov_b32 v51, 0
v_mov_b32 v52, 0
v_mov_b32 v53, 0
v_mov_b32 v54, 0
v_mov_b32 v55, 0
v_mov_b32 v56, 0
v_mov_b32 v57, 0
v_mov_b32 v58, 0
v_mov_b32 v59, 0
v_mov_b32 v60, 0
v_mov_b32 v61, 0
v_mov_b32 v62, 0
v_mov_b32 v63, 0
v_mov_b32 v64, 0
v_mov_b32 v65, 0
v_mov_b32 v66, 0
v_mov_b32 v67, 0
v_mov_b32 v68, 0
v_mov_b32 v69, 0
v_mov_b32 v70, 0
v_mov_b32 v71, 0
v_mov_b32 v72, 0
v_mov_b32 v73, 0
v_mov_b32 v74, 0
v_mov_b32 v75, 0
v_mov_b32 v76, 0
v_mov_b32 v77, 0
v_mov_b32 v78, 0
v_mov_b32 v79, 0
v_mov_b32 v80, 0
v_mov_b32 v81, 0
v_mov_b32 v82, 0
v_mov_b32 v83, 0
v_mov_b32 v84, 0
v_mov_b32 v85, 0
v_mov_b32 v86, 0
v_mov_b32 v87, 0
v_mov_b32 v88, 0
v_mov_b32 v89, 0
v_mov_b32 v90, 0
v_mov_b32 v91, 0
v_mov_b32 v92, 0
v_mov_b32 v93, 0
v_mov_b32 v94, 0
v_mov_b32 v95, 0
s_waitcnt vmcnt(6) lgkmcnt(0)
s_cmp_eq_u32 s94, 1
s_cbranch_scc0 K1_nord0
s_waitcnt vmcnt(0)
K1_nord0:
s_barrier
s_cmp_eq_u32 s20, 0
s_cselect_b32 s94, s94, 0
s_cmp_eq_u32 s94, 1
s_cbranch_scc0 K1_nordy
v_mov_b32 v244, 1
s_mov_b64 exec, 1
buffer_store_dword v244, off, s[52:55], 0 sc1
s_mov_b64 exec, -1
K1_nordy:
s_cmp_eq_u32 s23, 0
s_cbranch_scc1 K1_nogl3
v_lshlrev_b32 v240, 5, v185
s_lshl_b32 s35, s56, 11
buffer_load_dwordx4 v[188:191], v240, s[4:7], s35 offen
buffer_load_dwordx4 v[192:195], v240, s[4:7], s35 offen offset:16
buffer_load_dwordx4 v[196:199], v240, s[4:7], s35 offen offset:2048
buffer_load_dwordx4 v[200:203], v240, s[4:7], s35 offen offset:2064
buffer_load_dwordx4 v[204:207], v240, s[16:19], 0 offen
buffer_load_dwordx4 v[208:211], v240, s[16:19], 0 offen offset:16
K1_nogl3:
s_cmp_ge_u32 s20, 2
s_cbranch_scc1 K1_nowp
s_lshl_b32 s34, s20, 10
s_add_u32 m0, s34, 159744
s_lshl_b32 s35, s95, 11
s_add_u32 s35, s35, s34
v_lshlrev_b32 v241, 4, v185
buffer_load_dwordx4 v241, s[16:19], s35 offen lds
K1_nowp:
v_add_u32 v183, s68, v215
v_xor_b32 v184, 32, v183
s_add_u32 s68, s68, 12288
s_sub_u32 s35, s68, 61440
s_min_u32 s68, s68, s35
v_add_u32 v181, s69, v214
v_xor_b32 v182, 64, v181
s_add_u32 s69, s69, 32768
s_sub_u32 s35, s69, 98304
s_min_u32 s69, s69, s35
ds_read_b128 v[96:99], v181 offset:0
s_add_u32 m0, s31, 98304
s_nop 0
ds_read_b64_tr_b16 v[112:113], v183 offset:0
buffer_load_dwordx4 v180, s[8:11], s27 offen lds
s_add_u32 s27, s27, 393216
ds_read_b64_tr_b16 v[114:115], v183 offset:256
s_add_u32 s31, s31, 24576
s_sub_u32 s34, s31, 61440
s_min_u32 s31, s31, s34
s_add_u32 m0, s32, 98304
s_nop 0
ds_read_b128 v[100:103], v181 offset:2048
buffer_load_dwordx4 v180, s[8:11], s28 offen lds
s_add_u32 s28, s28, 393216
ds_read_b128 v[104:107], v181 offset:4096
s_add_u32 s32, s32, 24576
s_sub_u32 s34, s32, 61440
s_min_u32 s32, s32, s34
ds_read_b128 v[108:111], v181 offset:6144
s_add_u32 m0, s33, 98304
s_nop 0
ds_read_b64_tr_b16 v[116:117], v184 offset:0
buffer_load_dwordx4 v180, s[8:11], s29 offen lds
s_add_u32 s29, s29, 393216
ds_read_b64_tr_b16 v[118:119], v184 offset:256
s_add_u32 s33, s33, 24576
s_sub_u32 s34, s33, 61440
s_min_u32 s33, s33, s34
ds_read_b64_tr_b16 v[120:121], v183 offset:1024
ds_read_b64_tr_b16 v[122:123], v183 offset:1280
ds_read_b64_tr_b16 v[124:125], v184 offset:1024
ds_read_b64_tr_b16 v[126:127], v184 offset:1280
ds_read_b64_tr_b16 v[128:129], v183 offset:2048
ds_read_b64_tr_b16 v[130:131], v183 offset:2304
ds_read_b64_tr_b16 v[132:133], v184 offset:2048
ds_read_b64_tr_b16 v[134:135], v184 offset:2304
s_add_u32 m0, s30, 0
s_nop 0
buffer_load_dwordx4 v176, s[4:7], s26 offen lds
s_waitcnt lgkmcnt(0)
v_add_u32 v183, s68, v215
v_xor_b32 v184, 32, v183
s_add_u32 s68, s68, 12288
s_sub_u32 s35, s68, 61440
s_min_u32 s68, s68, s35
v_mfma_f32_16x16x32_bf16 v[0:3], v[112:115], v[96:99], v[0:3]
ds_read_b128 v[136:139], v182 offset:0
v_mfma_f32_16x16x32_bf16 v[4:7], v[112:115], v[100:103], v[4:7]
ds_read_b64_tr_b16 v[152:153], v183 offset:0
v_mfma_f32_16x16x32_bf16 v[8:11], v[112:115], v[104:107], v[8:11]
ds_read_b64_tr_b16 v[154:155], v183 offset:256
s_add_u32 m0, s30, 1024
v_mfma_f32_16x16x32_bf16 v[12:15], v[112:115], v[108:111], v[12:15]
ds_read_b128 v[140:143], v182 offset:2048
buffer_load_dwordx4 v177, s[4:7], s26 offen lds
v_mfma_f32_16x16x32_bf16 v[16:19], v[116:119], v[96:99], v[16:19]
ds_read_b128 v[144:147], v182 offset:4096
v_mfma_f32_16x16x32_bf16 v[20:23], v[116:119], v[100:103], v[20:23]
ds_read_b128 v[148:151], v182 offset:6144
v_mfma_f32_16x16x32_bf16 v[24:27], v[116:119], v[104:107], v[24:27]
ds_read_b64_tr_b16 v[156:157], v184 offset:0
v_mfma_f32_16x16x32_bf16 v[28:31], v[116:119], v[108:111], v[28:31]
ds_read_b64_tr_b16 v[158:159], v184 offset:256
v_mfma_f32_16x16x32_bf16 v[32:35], v[120:123], v[96:99], v[32:35]
ds_read_b64_tr_b16 v[160:161], v183 offset:1024
s_add_u32 m0, s30, 2048
v_mfma_f32_16x16x32_bf16 v[36:39], v[120:123], v[100:103], v[36:39]
ds_read_b64_tr_b16 v[162:163], v183 offset:1280
buffer_load_dwordx4 v178, s[4:7], s26 offen lds
v_mfma_f32_16x16x32_bf16 v[40:43], v[120:123], v[104:107], v[40:43]
ds_read_b64_tr_b16 v[164:165], v184 offset:1024
buffer_load_dword v213, v212, s[8:11], s64 offen
s_add_u32 s64, s64, 393216
s_min_u32 s64, s64, s65
v_mfma_f32_16x16x32_bf16 v[44:47], v[120:123], v[108:111], v[44:47]
ds_read_b64_tr_b16 v[166:167], v184 offset:1280
v_mfma_f32_16x16x32_bf16 v[48:51], v[124:127], v[96:99], v[48:51]
ds_read_b64_tr_b16 v[168:169], v183 offset:2048
v_mfma_f32_16x16x32_bf16 v[52:55], v[124:127], v[100:103], v[52:55]
ds_read_b64_tr_b16 v[170:171], v183 offset:2304
v_mfma_f32_16x16x32_bf16 v[56:59], v[124:127], v[104:107], v[56:59]
ds_read_b64_tr_b16 v[172:173], v184 offset:2048
s_add_u32 m0, s30, 3072
v_mfma_f32_16x16x32_bf16 v[60:63], v[124:127], v[108:111], v[60:63]
ds_read_b64_tr_b16 v[174:175], v184 offset:2304
buffer_load_dwordx4 v179, s[4:7], s26 offen lds
v_mfma_f32_16x16x32_bf16 v[64:67], v[96:99], v[128:131], v[64:67]
s_add_u32 s26, s26, 128
s_add_u32 s30, s30, 32768
s_sub_u32 s34, s30, 98304
s_min_u32 s30, s30, s34
v_mfma_f32_16x16x32_bf16 v[72:75], v[100:103], v[128:131], v[72:75]
v_mfma_f32_16x16x32_bf16 v[80:83], v[104:107], v[128:131], v[80:83]
v_mfma_f32_16x16x32_bf16 v[88:91], v[108:111], v[128:131], v[88:91]
v_mfma_f32_16x16x32_bf16 v[68:71], v[96:99], v[132:135], v[68:71]
v_mfma_f32_16x16x32_bf16 v[76:79], v[100:103], v[132:135], v[76:79]
v_mfma_f32_16x16x32_bf16 v[84:87], v[104:107], v[132:135], v[84:87]
v_mfma_f32_16x16x32_bf16 v[92:95], v[108:111], v[132:135], v[92:95]
s_mov_b32 s90, 13
s_branch K1_loop
.p2alignl 12, 0xbf810000
K1_loop:
s_waitcnt vmcnt(6) lgkmcnt(0)
s_barrier
v_add_u32 v183, s68, v215
v_xor_b32 v184, 32, v183
s_add_u32 s68, s68, 12288
s_sub_u32 s35, s68, 61440
s_min_u32 s68, s68, s35
v_add_u32 v181, s69, v214
v_xor_b32 v182, 64, v181
s_add_u32 s69, s69, 32768
s_sub_u32 s35, s69, 98304
s_min_u32 s69, s69, s35
v_mfma_f32_16x16x32_bf16 v[0:3], v[152:155], v[136:139], v[0:3]
ds_read_b128 v[96:99], v181 offset:0
s_add_u32 m0, s31, 98304
v_mfma_f32_16x16x32_bf16 v[4:7], v[152:155], v[140:143], v[4:7]
ds_read_b64_tr_b16 v[112:113], v183 offset:0
buffer_load_dwordx4 v180, s[8:11], s27 offen lds
s_add_u32 s27, s27, 393216
v_mfma_f32_16x16x32_bf16 v[8:11], v[152:155], v[144:147], v[8:11]
ds_read_b64_tr_b16 v[114:115], v183 offset:256
s_add_u32 s31, s31, 24576
s_sub_u32 s34, s31, 61440
s_min_u32 s31, s31, s34
s_add_u32 m0, s32, 98304
v_mfma_f32_16x16x32_bf16 v[12:15], v[152:155], v[148:151], v[12:15]
ds_read_b128 v[100:103], v181 offset:2048
buffer_load_dwordx4 v180, s[8:11], s28 offen lds
s_add_u32 s28, s28, 393216
v_mfma_f32_16x16x32_bf16 v[16:19], v[156:159], v[136:139], v[16:19]
ds_read_b128 v[104:107], v181 offset:4096
s_add_u32 s32, s32, 24576
s_sub_u32 s34, s32, 61440
s_min_u32 s32, s32, s34
v_mfma_f32_16x16x32_bf16 v[20:23], v[156:159], v[140:143], v[20:23]
ds_read_b128 v[108:111], v181 offset:6144
s_add_u32 m0, s33, 98304
v_mfma_f32_16x16x32_bf16 v[24:27], v[156:159], v[144:147], v[24:27]
ds_read_b64_tr_b16 v[116:117], v184 offset:0
buffer_load_dwordx4 v180, s[8:11], s29 offen lds
s_add_u32 s29, s29, 393216
v_mfma_f32_16x16x32_bf16 v[28:31], v[156:159], v[148:151], v[28:31]
ds_read_b64_tr_b16 v[118:119], v184 offset:256
s_add_u32 s33, s33, 24576
s_sub_u32 s34, s33, 61440
s_min_u32 s33, s33, s34
v_mfma_f32_16x16x32_bf16 v[32:35], v[160:163], v[136:139], v[32:35]
ds_read_b64_tr_b16 v[120:121], v183 offset:1024
v_mfma_f32_16x16x32_bf16 v[36:39], v[160:163], v[140:143], v[36:39]
ds_read_b64_tr_b16 v[122:123], v183 offset:1280
v_mfma_f32_16x16x32_bf16 v[40:43], v[160:163], v[144:147], v[40:43]
ds_read_b64_tr_b16 v[124:125], v184 offset:1024
v_mfma_f32_16x16x32_bf16 v[44:47], v[160:163], v[148:151], v[44:47]
ds_read_b64_tr_b16 v[126:127], v184 offset:1280
v_mfma_f32_16x16x32_bf16 v[48:51], v[164:167], v[136:139], v[48:51]
ds_read_b64_tr_b16 v[128:129], v183 offset:2048
v_mfma_f32_16x16x32_bf16 v[52:55], v[164:167], v[140:143], v[52:55]
ds_read_b64_tr_b16 v[130:131], v183 offset:2304
v_mfma_f32_16x16x32_bf16 v[56:59], v[164:167], v[144:147], v[56:59]
ds_read_b64_tr_b16 v[132:133], v184 offset:2048
v_mfma_f32_16x16x32_bf16 v[60:63], v[164:167], v[148:151], v[60:63]
ds_read_b64_tr_b16 v[134:135], v184 offset:2304
v_mfma_f32_16x16x32_bf16 v[64:67], v[136:139], v[168:171], v[64:67]
s_add_u32 m0, s30, 0
v_mfma_f32_16x16x32_bf16 v[72:75], v[140:143], v[168:171], v[72:75]
buffer_load_dwordx4 v176, s[4:7], s26 offen lds
v_mfma_f32_16x16x32_bf16 v[80:83], v[144:147], v[168:171], v[80:83]
v_mfma_f32_16x16x32_bf16 v[88:91], v[148:151], v[168:171], v[88:91]
v_mfma_f32_16x16x32_bf16 v[68:71], v[136:139], v[172:175], v[68:71]
v_mfma_f32_16x16x32_bf16 v[76:79], v[140:143], v[172:175], v[76:79]
v_mfma_f32_16x16x32_bf16 v[84:87], v[144:147], v[172:175], v[84:87]
v_mfma_f32_16x16x32_bf16 v[92:95], v[148:151], v[172:175], v[92:95]
s_waitcnt lgkmcnt(0)
v_add_u32 v183, s68, v215
v_xor_b32 v184, 32, v183
s_add_u32 s68, s68, 12288
s_sub_u32 s35, s68, 61440
s_min_u32 s68, s68, s35
v_mfma_f32_16x16x32_bf16 v[0:3], v[112:115], v[96:99], v[0:3]
ds_read_b128 v[136:139], v182 offset:0
v_mfma_f32_16x16x32_bf16 v[4:7], v[112:115], v[100:103], v[4:7]
ds_read_b64_tr_b16 v[152:153], v183 offset:0
v_mfma_f32_16x16x32_bf16 v[8:11], v[112:115], v[104:107], v[8:11]
ds_read_b64_tr_b16 v[154:155], v183 offset:256
s_add_u32 m0, s30, 1024
v_mfma_f32_16x16x32_bf16 v[12:15], v[112:115], v[108:111], v[12:15]
ds_read_b128 v[140:143], v182 offset:2048
buffer_load_dwordx4 v177, s[4:7], s26 offen lds
v_mfma_f32_16x16x32_bf16 v[16:19], v[116:119], v[96:99], v[16:19]
ds_read_b128 v[144:147], v182 offset:4096
v_mfma_f32_16x16x32_bf16 v[20:23], v[116:119], v[100:103], v[20:23]
ds_read_b128 v[148:151], v182 offset:6144
v_mfma_f32_16x16x32_bf16 v[24:27], v[116:119], v[104:107], v[24:27]
ds_read_b64_tr_b16 v[156:157], v184 offset:0
v_mfma_f32_16x16x32_bf16 v[28:31], v[116:119], v[108:111], v[28:31]
ds_read_b64_tr_b16 v[158:159], v184 offset:256
v_mfma_f32_16x16x32_bf16 v[32:35], v[120:123], v[96:99], v[32:35]
ds_read_b64_tr_b16 v[160:161], v183 offset:1024
s_add_u32 m0, s30, 2048
v_mfma_f32_16x16x32_bf16 v[36:39], v[120:123], v[100:103], v[36:39]
ds_read_b64_tr_b16 v[162:163], v183 offset:1280
buffer_load_dwordx4 v178, s[4:7], s26 offen lds
v_mfma_f32_16x16x32_bf16 v[40:43], v[120:123], v[104:107], v[40:43]
ds_read_b64_tr_b16 v[164:165], v184 offset:1024
buffer_load_dword v213, v212, s[8:11], s64 offen
s_add_u32 s64, s64, 393216
s_min_u32 s64, s64, s65
v_mfma_f32_16x16x32_bf16 v[44:47], v[120:123], v[108:111], v[44:47]
ds_read_b64_tr_b16 v[166:167], v184 offset:1280
v_mfma_f32_16x16x32_bf16 v[48:51], v[124:127], v[96:99], v[48:51]
ds_read_b64_tr_b16 v[168:169], v183 offset:2048
v_mfma_f32_16x16x32_bf16 v[52:55], v[124:127], v[100:103], v[52:55]
ds_read_b64_tr_b16 v[170:171], v183 offset:2304
v_mfma_f32_16x16x32_bf16 v[56:59], v[124:127], v[104:107], v[56:59]
ds_read_b64_tr_b16 v[172:173], v184 offset:2048
s_add_u32 m0, s30, 3072
v_mfma_f32_16x16x32_bf16 v[60:63], v[124:127], v[108:111], v[60:63]
ds_read_b64_tr_b16 v[174:175], v184 offset:2304
buffer_load_dwordx4 v179, s[4:7], s26 offen lds
v_mfma_f32_16x16x32_bf16 v[64:67], v[96:99], v[128:131], v[64:67]
s_add_u32 s26, s26, 128
s_add_u32 s30, s30, 32768
s_sub_u32 s34, s30, 98304
s_min_u32 s30, s30, s34
v_mfma_f32_16x16x32_bf16 v[72:75], v[100:103], v[128:131], v[72:75]
v_mfma_f32_16x16x32_bf16 v[80:83], v[104:107], v[128:131], v[80:83]
v_mfma_f32_16x16x32_bf16 v[88:91], v[108:111], v[128:131], v[88:91]
v_mfma_f32_16x16x32_bf16 v[68:71], v[96:99], v[132:135], v[68:71]
v_mfma_f32_16x16x32_bf16 v[76:79], v[100:103], v[132:135], v[76:79]
v_mfma_f32_16x16x32_bf16 v[84:87], v[104:107], v[132:135], v[84:87]
v_mfma_f32_16x16x32_bf16 v[92:95], v[108:111], v[132:135], v[92:95]
s_sub_u32 s90, s90, 1
s_cmp_lg_u32 s90, 0
s_cbranch_scc1 K1_loop
s_waitcnt vmcnt(6) lgkmcnt(0)
s_barrier
buffer_load_dword v239, off, s[52:55], 0 sc1
v_add_u32 v183, s68, v215
v_xor_b32 v184, 32, v183
s_add_u32 s68, s68, 12288
s_sub_u32 s35, s68, 61440
s_min_u32 s68, s68, s35
v_add_u32 v181, s69, v214
v_xor_b32 v182, 64, v181
s_add_u32 s69, s69, 32768
s_sub_u32 s35, s69, 98304
s_min_u32 s69, s69, s35
v_mfma_f32_16x16x32_bf16 v[0:3], v[152:155], v[136:139], v[0:3]
ds_read_b128 v[96:99], v181 offset:0
s_add_u32 m0, s31, 98304
v_mfma_f32_16x16x32_bf16 v[4:7], v[152:155], v[140:143], v[4:7]
ds_read_b64_tr_b16 v[112:113], v183 offset:0
buffer_load_dwordx4 v180, s[8:11], s27 offen lds
s_add_u32 s27, s27, 393216
v_mfma_f32_16x16x32_bf16 v[8:11], v[152:155], v[144:147], v[8:11]
ds_read_b64_tr_b16 v[114:115], v183 offset:256
s_add_u32 s31, s31, 24576
s_sub_u32 s34, s31, 61440
s_min_u32 s31, s31, s34
v_mfma_f32_16x16x32_bf16 v[12:15], v[152:155], v[148:151], v[12:15]
ds_read_b128 v[100:103], v181 offset:2048
v_mfma_f32_16x16x32_bf16 v[16:19], v[156:159], v[136:139], v[16:19]
ds_read_b128 v[104:107], v181 offset:4096
v_mfma_f32_16x16x32_bf16 v[20:23], v[156:159], v[140:143], v[20:23]
ds_read_b128 v[108:111], v181 offset:6144
v_mfma_f32_16x16x32_bf16 v[24:27], v[156:159], v[144:147], v[24:27]
ds_read_b64_tr_b16 v[116:117], v184 offset:0
v_mfma_f32_16x16x32_bf16 v[28:31], v[156:159], v[148:151], v[28:31]
ds_read_b64_tr_b16 v[118:119], v184 offset:256
v_mfma_f32_16x16x32_bf16 v[32:35], v[160:163], v[136:139], v[32:35]
ds_read_b64_tr_b16 v[120:121], v183 offset:1024
v_mfma_f32_16x16x32_bf16 v[36:39], v[160:163], v[140:143], v[36:39]
ds_read_b64_tr_b16 v[122:123], v183 offset:1280
v_mfma_f32_16x16x32_bf16 v[40:43], v[160:163], v[144:147], v[40:43]
ds_read_b64_tr_b16 v[124:125], v184 offset:1024
v_mfma_f32_16x16x32_bf16 v[44:47], v[160:163], v[148:151], v[44:47]
ds_read_b64_tr_b16 v[126:127], v184 offset:1280
v_mfma_f32_16x16x32_bf16 v[48:51], v[164:167], v[136:139], v[48:51]
ds_read_b64_tr_b16 v[128:129], v183 offset:2048
v_mfma_f32_16x16x32_bf16 v[52:55], v[164:167], v[140:143], v[52:55]
ds_read_b64_tr_b16 v[130:131], v183 offset:2304
v_mfma_f32_16x16x32_bf16 v[56:59], v[164:167], v[144:147], v[56:59]
ds_read_b64_tr_b16 v[132:133], v184 offset:2048
v_mfma_f32_16x16x32_bf16 v[60:63], v[164:167], v[148:151], v[60:63]
ds_read_b64_tr_b16 v[134:135], v184 offset:2304
v_mfma_f32_16x16x32_bf16 v[64:67], v[136:139], v[168:171], v[64:67]
v_mfma_f32_16x16x32_bf16 v[72:75], v[140:143], v[168:171], v[72:75]
v_mfma_f32_16x16x32_bf16 v[80:83], v[144:147], v[168:171], v[80:83]
v_mfma_f32_16x16x32_bf16 v[88:91], v[148:151], v[168:171], v[88:91]
v_mfma_f32_16x16x32_bf16 v[68:71], v[136:139], v[172:175], v[68:71]
v_mfma_f32_16x16x32_bf16 v[76:79], v[140:143], v[172:175], v[76:79]
v_mfma_f32_16x16x32_bf16 v[84:87], v[144:147], v[172:175], v[84:87]
v_mfma_f32_16x16x32_bf16 v[92:95], v[148:151], v[172:175], v[92:95]
s_bitcmp1_b32 s20, 1
s_cbranch_scc1 K1_sk_1
s_add_u32 m0, s32, 98304
s_nop 0
buffer_load_dwordx4 v180, s[8:11], s28 offen lds
s_add_u32 s28, s28, 393216
K1_sk_1:
s_waitcnt lgkmcnt(0)
v_add_u32 v183, s68, v215
v_xor_b32 v184, 32, v183
s_add_u32 s68, s68, 12288
s_sub_u32 s35, s68, 61440
s_min_u32 s68, s68, s35
v_mfma_f32_16x16x32_bf16 v[0:3], v[112:115], v[96:99], v[0:3]
ds_read_b128 v[136:139], v182 offset:0
v_mfma_f32_16x16x32_bf16 v[4:7], v[112:115], v[100:103], v[4:7]
ds_read_b64_tr_b16 v[152:153], v183 offset:0
v_mfma_f32_16x16x32_bf16 v[8:11], v[112:115], v[104:107], v[8:11]
ds_read_b64_tr_b16 v[154:155], v183 offset:256
v_mfma_f32_16x16x32_bf16 v[12:15], v[112:115], v[108:111], v[12:15]
ds_read_b128 v[140:143], v182 offset:2048
v_mfma_f32_16x16x32_bf16 v[16:19], v[116:119], v[96:99], v[16:19]
ds_read_b128 v[144:147], v182 offset:4096
v_mfma_f32_16x16x32_bf16 v[20:23], v[116:119], v[100:103], v[20:23]
ds_read_b128 v[148:151], v182 offset:6144
v_mfma_f32_16x16x32_bf16 v[24:27], v[116:119], v[104:107], v[24:27]
ds_read_b64_tr_b16 v[156:157], v184 offset:0
v_mfma_f32_16x16x32_bf16 v[28:31], v[116:119], v[108:111], v[28:31]
ds_read_b64_tr_b16 v[158:159], v184 offset:256
v_mfma_f32_16x16x32_bf16 v[32:35], v[120:123], v[96:99], v[32:35]
ds_read_b64_tr_b16 v[160:161], v183 offset:1024
v_mfma_f32_16x16x32_bf16 v[36:39], v[120:123], v[100:103], v[36:39]
ds_read_b64_tr_b16 v[162:163], v183 offset:1280
v_mfma_f32_16x16x32_bf16 v[40:43], v[120:123], v[104:107], v[40:43]
ds_read_b64_tr_b16 v[164:165], v184 offset:1024
v_mfma_f32_16x16x32_bf16 v[44:47], v[120:123], v[108:111], v[44:47]
ds_read_b64_tr_b16 v[166:167], v184 offset:1280
v_mfma_f32_16x16x32_bf16 v[48:51], v[124:127], v[96:99], v[48:51]
ds_read_b64_tr_b16 v[168:169], v183 offset:2048
v_mfma_f32_16x16x32_bf16 v[52:55], v[124:127], v[100:103], v[52:55]
ds_read_b64_tr_b16 v[170:171], v183 offset:2304
v_mfma_f32_16x16x32_bf16 v[56:59], v[124:127], v[104:107], v[56:59]
ds_read_b64_tr_b16 v[172:173], v184 offset:2048
v_mfma_f32_16x16x32_bf16 v[60:63], v[124:127], v[108:111], v[60:63]
ds_read_b64_tr_b16 v[174:175], v184 offset:2304
v_mfma_f32_16x16x32_bf16 v[64:67], v[96:99], v[128:131], v[64:67]
v_mfma_f32_16x16x32_bf16 v[72:75], v[100:103], v[128:131], v[72:75]
v_mfma_f32_16x16x32_bf16 v[80:83], v[104:107], v[128:131], v[80:83]
v_mfma_f32_16x16x32_bf16 v[88:91], v[108:111], v[128:131], v[88:91]
v_mfma_f32_16x16x32_bf16 v[68:71], v[96:99], v[132:135], v[68:71]
v_mfma_f32_16x16x32_bf16 v[76:79], v[100:103], v[132:135], v[76:79]
v_mfma_f32_16x16x32_bf16 v[84:87], v[104:107], v[132:135], v[84:87]
v_mfma_f32_16x16x32_bf16 v[92:95], v[108:111], v[132:135], v[92:95]
s_waitcnt vmcnt(0) lgkmcnt(0)
s_barrier
v_add_u32 v183, s68, v215
v_xor_b32 v184, 32, v183
s_add_u32 s68, s68, 12288
s_sub_u32 s35, s68, 61440
s_min_u32 s68, s68, s35
v_add_u32 v181, s69, v214
v_xor_b32 v182, 64, v181
s_add_u32 s69, s69, 32768
s_sub_u32 s35, s69, 98304
s_min_u32 s69, s69, s35
v_mfma_f32_16x16x32_bf16 v[0:3], v[152:155], v[136:139], v[0:3]
ds_read_b128 v[96:99], v181 offset:0
v_mfma_f32_16x16x32_bf16 v[4:7], v[152:155], v[140:143], v[4:7]
ds_read_b64_tr_b16 v[112:113], v183 offset:0
s_cmp_eq_u32 s23, 0
s_cbranch_scc1 K1_g1
s_mov_b32 s57, 0xffff0000
v_mov_b32 v216, 0
v_mov_b32 v217, 0
v_lshlrev_b32 v218, 16, v204
v_and_b32 v219, s57, v204
K1_g1:
v_mfma_f32_16x16x32_bf16 v[8:11], v[152:155], v[144:147], v[8:11]
ds_read_b64_tr_b16 v[114:115], v183 offset:256
s_cmp_eq_u32 s23, 0
s_cbranch_scc1 K1_g2
v_lshlrev_b32 v220, 16, v188
v_and_b32 v221, s57, v188
v_fmac_f32 v216, v218, v220
v_fmac_f32 v216, v219, v221
K1_g2:
v_mfma_f32_16x16x32_bf16 v[12:15], v[152:155], v[148:151], v[12:15]
ds_read_b128 v[100:103], v181 offset:2048
s_cmp_eq_u32 s23, 0
s_cbranch_scc1 K1_g3
v_lshlrev_b32 v220, 16, v196
v_and_b32 v221, s57, v196
v_fmac_f32 v217, v218, v220
v_fmac_f32 v217, v219, v221
K1_g3:
v_mfma_f32_16x16x32_bf16 v[16:19], v[156:159], v[136:139], v[16:19]
ds_read_b128 v[104:107], v181 offset:4096
s_cmp_eq_u32 s23, 0
s_cbranch_scc1 K1_g4
v_lshlrev_b32 v218, 16, v205
v_and_b32 v219, s57, v205
v_lshlrev_b32 v220, 16, v189
v_and_b32 v221, s57, v189
K1_g4:
v_mfma_f32_16x16x32_bf16 v[20:23], v[156:159], v[140:143], v[20:23]
ds_read_b128 v[108:111], v181 offset:6144
s_cmp_eq_u32 s23, 0
s_cbranch_scc1 K1_g5
v_fmac_f32 v216, v218, v220
v_fmac_f32 v216, v219, v221
v_lshlrev_b32 v220, 16, v197
v_and_b32 v221, s57, v197
K1_g5:
v_mfma_f32_16x16x32_bf16 v[24:27], v[156:159], v[144:147], v[24:27]
ds_read_b64_tr_b16 v[116:117], v184 offset:0
s_cmp_eq_u32 s23, 0
s_cbranch_scc1 K1_g6
v_fmac_f32 v217, v218, v220
v_fmac_f32 v217, v219, v221
v_lshlrev_b32 v218, 16, v206
v_and_b32 v219, s57, v206
K1_g6:
v_mfma_f32_16x16x32_bf16 v[28:31], v[156:159], v[148:151], v[28:31]
ds_read_b64_tr_b16 v[118:119], v184 offset:256
s_cmp_eq_u32 s23, 0
s_cbranch_scc1 K1_g7
v_lshlrev_b32 v220, 16, v190
v_and_b32 v221, s57, v190
v_fmac_f32 v216, v218, v220
v_fmac_f32 v216, v219, v221
K1_g7:
v_mfma_f32_16x16x32_bf16 v[32:35], v[160:163], v[136:139], v[32:35]
ds_read_b64_tr_b16 v[120:121], v183 offset:1024
s_cmp_eq_u32 s23, 0
s_cbranch_scc1 K1_g8
v_lshlrev_b32 v220, 16, v198
v_and_b32 v221, s57, v198
v_fmac_f32 v217, v218, v220
v_fmac_f32 v217, v219, v221
K1_g8:
v_mfma_f32_16x16x32_bf16 v[36:39], v[160:163], v[140:143], v[36:39]
ds_read_b64_tr_b16 v[122:123], v183 offset:1280
s_cmp_eq_u32 s23, 0
s_cbranch_scc1 K1_g9
v_lshlrev_b32 v218, 16, v207
v_and_b32 v219, s57, v207
v_lshlrev_b32 v220, 16, v191
v_and_b32 v221, s57, v191
K1_g9:
v_mfma_f32_16x16x32_bf16 v[40:43], v[160:163], v[144:147], v[40:43]
ds_read_b64_tr_b16 v[124:125], v184 offset:1024
s_cmp_eq_u32 s23, 0
s_cbranch_scc1 K1_g10
v_fmac_f32 v216, v218, v220
v_fmac_f32 v216, v219, v221
v_lshlrev_b32 v220, 16, v199
v_and_b32 v221, s57, v199
K1_g10:
v_mfma_f32_16x16x32_bf16 v[44:47], v[160:163], v[148:151], v[44:47]
ds_read_b64_tr_b16 v[126:127], v184 offset:1280
s_cmp_eq_u32 s23, 0
s_cbranch_scc1 K1_g11
v_fmac_f32 v217, v218, v220
v_fmac_f32 v217, v219, v221
v_lshlrev_b32 v218, 16, v208
v_and_b32 v219, s57, v208
K1_g11:
v_mfma_f32_16x16x32_bf16 v[48:51], v[164:167], v[136:139], v[48:51]
ds_read_b64_tr_b16 v[128:129], v183 offset:2048
v_mfma_f32_16x16x32_bf16 v[52:55], v[164:167], v[140:143], v[52:55]
ds_read_b64_tr_b16 v[130:131], v183 offset:2304
v_mfma_f32_16x16x32_bf16 v[56:59], v[164:167], v[144:147], v[56:59]
ds_read_b64_tr_b16 v[132:133], v184 offset:2048
v_mfma_f32_16x16x32_bf16 v[60:63], v[164:167], v[148:151], v[60:63]
ds_read_b64_tr_b16 v[134:135], v184 offset:2304
v_mfma_f32_16x16x32_bf16 v[64:67], v[136:139], v[168:171], v[64:67]
v_mfma_f32_16x16x32_bf16 v[72:75], v[140:143], v[168:171], v[72:75]
v_mfma_f32_16x16x32_bf16 v[80:83], v[144:147], v[168:171], v[80:83]
v_mfma_f32_16x16x32_bf16 v[88:91], v[148:151], v[168:171], v[88:91]
v_mfma_f32_16x16x32_bf16 v[68:71], v[136:139], v[172:175], v[68:71]
v_mfma_f32_16x16x32_bf16 v[76:79], v[140:143], v[172:175], v[76:79]
v_mfma_f32_16x16x32_bf16 v[84:87], v[144:147], v[172:175], v[84:87]
v_mfma_f32_16x16x32_bf16 v[92:95], v[148:151], v[172:175], v[92:95]
s_waitcnt lgkmcnt(0)
v_add_u32 v183, s68, v215
v_xor_b32 v184, 32, v183
s_add_u32 s68, s68, 12288
s_sub_u32 s35, s68, 61440
s_min_u32 s68, s68, s35
v_mfma_f32_16x16x32_bf16 v[0:3], v[112:115], v[96:99], v[0:3]
ds_read_b128 v[136:139], v182 offset:0
v_mfma_f32_16x16x32_bf16 v[4:7], v[112:115], v[100:103], v[4:7]
ds_read_b64_tr_b16 v[152:153], v183 offset:0
s_cmp_eq_u32 s23, 0
s_cbranch_scc1 K1_g12
v_lshlrev_b32 v220, 16, v192
v_and_b32 v221, s57, v192
v_fmac_f32 v216, v218, v220
v_fmac_f32 v216, v219, v221
K1_g12:
v_mfma_f32_16x16x32_bf16 v[8:11], v[112:115], v[104:107], v[8:11]
ds_read_b64_tr_b16 v[154:155], v183 offset:256
s_cmp_eq_u32 s23, 0
s_cbranch_scc1 K1_g13
v_lshlrev_b32 v220, 16, v200
v_and_b32 v221, s57, v200
v_fmac_f32 v217, v218, v220
v_fmac_f32 v217, v219, v221
K1_g13:
v_mfma_f32_16x16x32_bf16 v[12:15], v[112:115], v[108:111], v[12:15]
ds_read_b128 v[140:143], v182 offset:2048
s_cmp_eq_u32 s23, 0
s_cbranch_scc1 K1_g14
v_lshlrev_b32 v218, 16, v209
v_and_b32 v219, s57, v209
v_lshlrev_b32 v220, 16, v193
v_and_b32 v221, s57, v193
K1_g14:
v_mfma_f32_16x16x32_bf16 v[16:19], v[116:119], v[96:99], v[16:19]
ds_read_b128 v[144:147], v182 offset:4096
s_cmp_eq_u32 s23, 0
s_cbranch_scc1 K1_g15
v_fmac_f32 v216, v218, v220
v_fmac_f32 v216, v219, v221
v_lshlrev_b32 v220, 16, v201
v_and_b32 v221, s57, v201
K1_g15:
v_mfma_f32_16x16x32_bf16 v[20:23], v[116:119], v[100:103], v[20:23]
ds_read_b128 v[148:151], v182 offset:6144
s_cmp_eq_u32 s23, 0
s_cbranch_scc1 K1_g16
v_fmac_f32 v217, v218, v220
v_fmac_f32 v217, v219, v221
v_lshlrev_b32 v218, 16, v210
v_and_b32 v219, s57, v210
K1_g16:
v_mfma_f32_16x16x32_bf16 v[24:27], v[116:119], v[104:107], v[24:27]
ds_read_b64_tr_b16 v[156:157], v184 offset:0
s_cmp_eq_u32 s23, 0
s_cbranch_scc1 K1_g17
v_lshlrev_b32 v220, 16, v194
v_and_b32 v221, s57, v194
v_fmac_f32 v216, v218, v220
v_fmac_f32 v216, v219, v221
K1_g17:
v_mfma_f32_16x16x32_bf16 v[28:31], v[116:119], v[108:111], v[28:31]
ds_read_b64_tr_b16 v[158:159], v184 offset:256
s_cmp_eq_u32 s23, 0
s_cbranch_scc1 K1_g18
v_lshlrev_b32 v220, 16, v202
v_and_b32 v221, s57, v202
v_fmac_f32 v217, v218, v220
v_fmac_f32 v217, v219, v221
K1_g18:
v_mfma_f32_16x16x32_bf16 v[32:35], v[120:123], v[96:99], v[32:35]
ds_read_b64_tr_b16 v[160:161], v183 offset:1024
s_cmp_eq_u32 s23, 0
s_cbranch_scc1 K1_g19
v_lshlrev_b32 v218, 16, v211
v_and_b32 v219, s57, v211
v_lshlrev_b32 v220, 16, v195
v_and_b32 v221, s57, v195
K1_g19:
v_mfma_f32_16x16x32_bf16 v[36:39], v[120:123], v[100:103], v[36:39]
ds_read_b64_tr_b16 v[162:163], v183 offset:1280
s_cmp_eq_u32 s23, 0
s_cbranch_scc1 K1_g20
v_fmac_f32 v216, v218, v220
v_fmac_f32 v216, v219, v221
v_lshlrev_b32 v220, 16, v203
v_and_b32 v221, s57, v203
K1_g20:
v_mfma_f32_16x16x32_bf16 v[40:43], v[120:123], v[104:107], v[40:43]
ds_read_b64_tr_b16 v[164:165], v184 offset:1024
s_cmp_eq_u32 s23, 0
s_cbranch_scc1 K1_g21
v_fmac_f32 v217, v218, v220
v_fmac_f32 v217, v219, v221
K1_g21:
v_mfma_f32_16x16x32_bf16 v[44:47], v[120:123], v[108:111], v[44:47]
ds_read_b64_tr_b16 v[166:167], v184 offset:1280
v_mfma_f32_16x16x32_bf16 v[48:51], v[124:127], v[96:99], v[48:51]
ds_read_b64_tr_b16 v[168:169], v183 offset:2048
v_mfma_f32_16x16x32_bf16 v[52:55], v[124:127], v[100:103], v[52:55]
ds_read_b64_tr_b16 v[170:171], v183 offset:2304
v_mfma_f32_16x16x32_bf16 v[56:59], v[124:127], v[104:107], v[56:59]
ds_read_b64_tr_b16 v[172:173], v184 offset:2048
v_mfma_f32_16x16x32_bf16 v[60:63], v[124:127], v[108:111], v[60:63]
ds_read_b64_tr_b16 v[174:175], v184 offset:2304
v_mfma_f32_16x16x32_bf16 v[64:67], v[96:99], v[128:131], v[64:67]
v_mfma_f32_16x16x32_bf16 v[72:75], v[100:103], v[128:131], v[72:75]
v_mfma_f32_16x16x32_bf16 v[80:83], v[104:107], v[128:131], v[80:83]
v_mfma_f32_16x16x32_bf16 v[88:91], v[108:111], v[128:131], v[88:91]
v_mfma_f32_16x16x32_bf16 v[68:71], v[96:99], v[132:135], v[68:71]
v_mfma_f32_16x16x32_bf16 v[76:79], v[100:103], v[132:135], v[76:79]
v_mfma_f32_16x16x32_bf16 v[84:87], v[104:107], v[132:135], v[84:87]
v_mfma_f32_16x16x32_bf16 v[92:95], v[108:111], v[132:135], v[92:95]
s_waitcnt lgkmcnt(0)
s_barrier
v_mfma_f32_16x16x32_bf16 v[0:3], v[152:155], v[136:139], v[0:3]
v_mfma_f32_16x16x32_bf16 v[4:7], v[152:155], v[140:143], v[4:7]
s_cmp_eq_u32 s23, 0
s_cbranch_scc1 K1_g22
v_add_f32_dpp v216, v216, v216 row_shr:1 row_mask:0xf bank_mask:0xf bound_ctrl:0
v_add_f32_dpp v217, v217, v217 row_shr:1 row_mask:0xf bank_mask:0xf bound_ctrl:0
K1_g22:
v_mfma_f32_16x16x32_bf16 v[8:11], v[152:155], v[144:147], v[8:11]
s_cmp_eq_u32 s23, 0
s_cbranch_scc1 K1_g23
v_add_f32_dpp v216, v216, v216 row_shr:2 row_mask:0xf bank_mask:0xf bound_ctrl:0
v_add_f32_dpp v217, v217, v217 row_shr:2 row_mask:0xf bank_mask:0xf bound_ctrl:0
K1_g23:
v_mfma_f32_16x16x32_bf16 v[12:15], v[152:155], v[148:151], v[12:15]
s_cmp_eq_u32 s23, 0
s_cbranch_scc1 K1_g24
v_add_f32_dpp v216, v216, v216 row_shr:4 row_mask:0xf bank_mask:0xf bound_ctrl:0
v_add_f32_dpp v217, v217, v217 row_shr:4 row_mask:0xf bank_mask:0xf bound_ctrl:0
K1_g24:
v_mfma_f32_16x16x32_bf16 v[16:19], v[156:159], v[136:139], v[16:19]
s_cmp_eq_u32 s23, 0
s_cbranch_scc1 K1_g25
v_add_f32_dpp v216, v216, v216 row_shr:8 row_mask:0xf bank_mask:0xf bound_ctrl:0
v_add_f32_dpp v217, v217, v217 row_shr:8 row_mask:0xf bank_mask:0xf bound_ctrl:0
K1_g25:
v_mfma_f32_16x16x32_bf16 v[20:23], v[156:159], v[140:143], v[20:23]
s_cmp_eq_u32 s23, 0
s_cbranch_scc1 K1_g26
v_add_f32_dpp v216, v216, v216 row_bcast:15 row_mask:0xa bank_mask:0xf
v_add_f32_dpp v217, v217, v217 row_bcast:15 row_mask:0xa bank_mask:0xf
K1_g26:
v_mfma_f32_16x16x32_bf16 v[24:27], v[156:159], v[144:147], v[24:27]
s_cmp_eq_u32 s23, 0
s_cbranch_scc1 K1_g27
v_add_f32_dpp v216, v216, v216 row_bcast:31 row_mask:0xc bank_mask:0xf
v_add_f32_dpp v217, v217, v217 row_bcast:31 row_mask:0xc bank_mask:0xf
K1_g27:
v_mfma_f32_16x16x32_bf16 v[28:31], v[156:159], v[148:151], v[28:31]
s_cmp_eq_u32 s23, 0
s_cbranch_scc1 K1_g28
s_mov_b32 s57, 0xbfb8aa3b
v_mul_f32 v216, s57, v216
v_mul_f32 v217, s57, v217
K1_g28:
v_mfma_f32_16x16x32_bf16 v[32:35], v[160:163], v[136:139], v[32:35]
s_cmp_eq_u32 s23, 0
s_cbranch_scc1 K1_g29
v_exp_f32 v216, v216
v_exp_f32 v217, v217
K1_g29:
v_mfma_f32_16x16x32_bf16 v[36:39], v[160:163], v[140:143], v[36:39]
s_cmp_eq_u32 s23, 0
s_cbranch_scc1 K1_g30
v_add_f32 v216, 1.0, v216
v_add_f32 v217, 1.0, v217
K1_g30:
v_mfma_f32_16x16x32_bf16 v[40:43], v[160:163], v[144:147], v[40:43]
s_cmp_eq_u32 s23, 0
s_cbranch_scc1 K1_g31
v_rcp_f32 v216, v216
v_rcp_f32 v217, v217
K1_g31:
v_mfma_f32_16x16x32_bf16 v[44:47], v[160:163], v[148:151], v[44:47]
s_cmp_eq_u32 s23, 0
s_cbranch_scc1 K1_g32
v_cmp_eq_u32 vcc, 63, v185
v_mov_b32 v218, 0x7ffff000
v_mov_b32 v219, 0
s_lshr_b32 s59, s56, 3
s_lshl_b32 s59, s59, 7
s_lshl_b32 s57, s24, 3
s_add_u32 s59, s59, s57
s_add_u32 s59, s59, 19398656
v_cndmask_b32 v218, v218, v219, vcc
buffer_store_dwordx2 v[216:217], v218, s[12:15], s59 offen sc1
K1_g32:
v_mfma_f32_16x16x32_bf16 v[48:51], v[164:167], v[136:139], v[48:51]
v_mfma_f32_16x16x32_bf16 v[52:55], v[164:167], v[140:143], v[52:55]
v_mfma_f32_16x16x32_bf16 v[56:59], v[164:167], v[144:147], v[56:59]
v_mfma_f32_16x16x32_bf16 v[60:63], v[164:167], v[148:151], v[60:63]
v_mfma_f32_16x16x32_bf16 v[64:67], v[136:139], v[168:171], v[64:67]
v_mfma_f32_16x16x32_bf16 v[72:75], v[140:143], v[168:171], v[72:75]
v_mfma_f32_16x16x32_bf16 v[80:83], v[144:147], v[168:171], v[80:83]
v_mfma_f32_16x16x32_bf16 v[88:91], v[148:151], v[168:171], v[88:91]
v_mfma_f32_16x16x32_bf16 v[68:71], v[136:139], v[172:175], v[68:71]
v_mfma_f32_16x16x32_bf16 v[76:79], v[140:143], v[172:175], v[76:79]
v_mfma_f32_16x16x32_bf16 v[84:87], v[144:147], v[172:175], v[84:87]
v_mfma_f32_16x16x32_bf16 v[92:95], v[148:151], v[172:175], v[92:95]
v_cmp_ne_u32 vcc, 1, v239
s_nop 1
s_cbranch_vccnz K1_spinR
K1_spinR_b:
s_lshl_b32 s58, s21, 3
s_lshl_b32 s34, s24, 1
s_add_u32 s58, s58, s34
s_lshl_b32 s95, s21, 5
s_add_u32 s95, s95, s22
s_lshl_b32 s95, s95, 5
s_add_u32 s95, s95, s24
s_lshl_b32 s95, s95, 2
s_add_u32 s95, s95, 19664896
s_cmp_eq_u32 s23, 0
s_cbranch_scc1 K1_epiA
s_mov_b32 s60, 0x3e8293ee
s_mov_b32 s61, 0x3e8293ee
s_lshl_b32 s63, s22, 18
s_lshl_b32 s34, s58, 12
s_add_u32 s63, s63, s34
s_add_u32 s63, s63, 0
s_add_u32 s64, s63, 4096
s_lshl_b32 s34, s24, 13
v_add_u32 v240, s34, v187
v_add_u32 v241, s34, v186
s_lshl_b32 s34, s24, 12
s_add_u32 s34, s34, 65536
v_add_u32 v242, s34, v186
v_cvt_pk_bf16_f32 v112, v32, v33
v_cvt_pk_bf16_f32 v113, v34, v35
v_cvt_pk_bf16_f32 v114, v48, v49
v_cvt_pk_bf16_f32 v115, v50, v51
v_cvt_pk_bf16_f32 v116, v36, v37
v_cvt_pk_bf16_f32 v117, v38, v39
v_cvt_pk_bf16_f32 v118, v52, v53
v_cvt_pk_bf16_f32 v119, v54, v55
v_cvt_pk_bf16_f32 v120, v40, v41
v_cvt_pk_bf16_f32 v121, v42, v43
v_cvt_pk_bf16_f32 v122, v56, v57
v_cvt_pk_bf16_f32 v123, v58, v59
v_cvt_pk_bf16_f32 v124, v44, v45
v_cvt_pk_bf16_f32 v125, v46, v47
v_cvt_pk_bf16_f32 v126, v60, v61
v_cvt_pk_bf16_f32 v127, v62, v63
buffer_store_dwordx4 v[112:115], v187, s[12:15], s63 offen offset:0 sc1
buffer_store_dwordx4 v[116:119], v187, s[12:15], s63 offen offset:64 sc1
buffer_store_dwordx4 v[120:123], v187, s[12:15], s64 offen offset:0 sc1
buffer_store_dwordx4 v[124:127], v187, s[12:15], s64 offen offset:64 sc1
v_cvt_pk_bf16_f32 v128, v64, v65
v_cvt_pk_bf16_f32 v129, v66, v67
v_cvt_pk_bf16_f32 v130, v72, v73
v_cvt_pk_bf16_f32 v131, v74, v75
v_cvt_pk_bf16_f32 v132, v68, v69
v_cvt_pk_bf16_f32 v133, v70, v71
v_cvt_pk_bf16_f32 v134, v76, v77
v_cvt_pk_bf16_f32 v135, v78, v79
v_cvt_pk_bf16_f32 v136, v80, v81
v_cvt_pk_bf16_f32 v137, v82, v83
v_cvt_pk_bf16_f32 v138, v88, v89
v_cvt_pk_bf16_f32 v139, v90, v91
v_cvt_pk_bf16_f32 v140, v84, v85
v_cvt_pk_bf16_f32 v141, v86, v87
v_cvt_pk_bf16_f32 v142, v92, v93
v_cvt_pk_bf16_f32 v143, v94, v95
buffer_store_dwordx4 v[128:131], v186, s[12:15], s63 offen offset:2048 sc1
buffer_store_dwordx4 v[132:135], v186, s[12:15], s63 offen offset:2304 sc1
buffer_store_dwordx4 v[136:139], v186, s[12:15], s64 offen offset:2048 sc1
buffer_store_dwordx4 v[140:143], v186, s[12:15], s64 offen offset:2304 sc1
v_pk_mul_f32 v[0:1], v[0:1], s[60:61]
v_pk_mul_f32 v[2:3], v[2:3], s[60:61]
v_pk_mul_f32 v[4:5], v[4:5], s[60:61]
v_pk_mul_f32 v[6:7], v[6:7], s[60:61]
v_pk_mul_f32 v[8:9], v[8:9], s[60:61]
v_pk_mul_f32 v[10:11], v[10:11], s[60:61]
v_pk_mul_f32 v[12:13], v[12:13], s[60:61]
v_pk_mul_f32 v[14:15], v[14:15], s[60:61]
v_pk_mul_f32 v[16:17], v[16:17], s[60:61]
v_pk_mul_f32 v[18:19], v[18:19], s[60:61]
v_pk_mul_f32 v[20:21], v[20:21], s[60:61]
v_pk_mul_f32 v[22:23], v[22:23], s[60:61]
v_pk_mul_f32 v[24:25], v[24:25], s[60:61]
v_pk_mul_f32 v[26:27], v[26:27], s[60:61]
v_pk_mul_f32 v[28:29], v[28:29], s[60:61]
v_pk_mul_f32 v[30:31], v[30:31], s[60:61]
ds_write_b128 v240, v[112:115] offset:0
ds_write_b128 v240, v[116:119] offset:64
ds_write_b128 v240, v[120:123] offset:4096
ds_write_b128 v240, v[124:127] offset:4160
v_cvt_pk_bf16_f32 v96, v0, v1
v_cvt_pk_bf16_f32 v97, v2, v3
v_cvt_pk_bf16_f32 v98, v16, v17
v_cvt_pk_bf16_f32 v99, v18, v19
v_cvt_pk_bf16_f32 v100, v4, v5
v_cvt_pk_bf16_f32 v101, v6, v7
v_cvt_pk_bf16_f32 v102, v20, v21
v_cvt_pk_bf16_f32 v103, v22, v23
v_cvt_pk_bf16_f32 v104, v8, v9
v_cvt_pk_bf16_f32 v105, v10, v11
v_cvt_pk_bf16_f32 v106, v24, v25
v_cvt_pk_bf16_f32 v107, v26, v27
v_cvt_pk_bf16_f32 v108, v12, v13
v_cvt_pk_bf16_f32 v109, v14, v15
v_cvt_pk_bf16_f32 v110, v28, v29
v_cvt_pk_bf16_f32 v111, v30, v31
ds_write_b128 v241, v[128:131] offset:2048
ds_write_b128 v241, v[132:135] offset:2304
ds_write_b128 v241, v[136:139] offset:6144
ds_write_b128 v241, v[140:143] offset:6400
ds_write_b128 v242, v[96:99] offset:0
ds_write_b128 v242, v[100:103] offset:256
ds_write_b128 v242, v[104:107] offset:2048
ds_write_b128 v242, v[108:111] offset:2304
s_and_b32 s3, s2, 7
s_lshr_b32 s69, s2, 3
v_mov_b32 v0, v185
v_lshlrev_b32 v1, 4, v0
s_and_b32 s65, s20, 3
s_lshl_b32 s34, s65, 1
s_lshl_b32 s30, s21, 3
s_add_u32 s30, s30, s34
s_add_u32 s30, s30, s23
s_add_u32 s35, s21, 1
s_and_b32 s35, s35, 7
s_lshl_b32 s24, s35, 15
s_lshl_b32 s34, s20, 12
s_add_u32 s24, s24, s34
s_add_u32 s25, s34, 32768
s_lshl_b32 s34, s22, 18
v_add_u32 v190, s34, v1
s_lshl_b32 s100, s22, 5
s_lshr_b32 s34, s20, 1
s_add_u32 s100, s100, s34
s_lshl_b32 s100, s100, 2
s_add_u32 s100, s100, 19664896
s_lshl_b32 s35, s35, 12
s_add_u32 s101, s100, s35
s_add_u32 s35, s21, 2
s_and_b32 s35, s35, 7
s_lshl_b32 s35, s35, 12
s_add_u32 s64, s100, s35
v_and_b32 v4, 31, v0
v_and_b32 v5, 7, v4
v_lshlrev_b32 v5, 12, v5
v_add_u32 v5, s100, v5
v_add_u32 v6, 16, v5
v_cmp_gt_u32 vcc, 8, v4
s_and_b32 s34, s30, 7
s_lshl_b32 s34, s34, 9
v_cndmask_b32 v5, v5, v6, vcc
s_lshl_b32 s35, s21, 12
s_add_u32 s34, s34, s35
s_add_u32 s34, s34, 19664896
v_subrev_u32 v6, 8, v4
v_bfe_u32 v7, v6, 2, 2
v_lshlrev_b32 v7, 7, v7
v_add_u32 v7, s34, v7
v_cmp_gt_u32 vcc, 16, v6
v_and_b32 v6, 3, v6
v_lshl_add_u32 v7, v6, 2, v7
v_cndmask_b32 v188, v5, v7, vcc
s_mov_b32 s4, s42
s_mov_b32 s5, s43
s_mov_b32 s6, 2097152
s_mov_b32 s7, 0x20000
s_mov_b32 s8, s44
s_mov_b32 s9, s45
s_mov_b32 s10, 2097152
s_mov_b32 s11, 0x20000
s_mov_b32 s16, s96
s_mov_b32 s17, s97
s_mov_b32 s18, 4194304
s_mov_b32 s19, 0x20000
s_lshr_b32 s34, s30, 2
s_lshl_b32 s34, s34, 6
s_add_u32 s34, s34, s22
s_lshl_b32 s34, s34, 2
s_and_b32 s35, s30, 3
s_add_u32 s34, s34, s35
s_lshl_b32 s29, s34, 11
s_add_u32 s29, s29, 20971520
v_and_b32 v4, 7, v0
v_mov_b32 v5, 0x3f803f80
v_mov_b32 v6, 0
v_cmp_eq_u32 vcc, 0, v4
v_cmp_eq_u32 s[34:35], 4, v4
v_mov_b32 v189, 0xdddddddd
v_cndmask_b32 v168, v6, v5, vcc
v_cndmask_b32 v169, v6, v5, vcc
v_cndmask_b32 v170, v6, v5, s[34:35]
v_cndmask_b32 v171, v6, v5, s[34:35]
v_mov_b32 v128, 0
v_mov_b32 v129, 0
v_mov_b32 v130, 0
v_mov_b32 v131, 0
v_mov_b32 v132, 0
v_mov_b32 v133, 0
v_mov_b32 v134, 0
v_mov_b32 v135, 0
v_mov_b32 v136, 0
v_mov_b32 v137, 0
v_mov_b32 v138, 0
v_mov_b32 v139, 0
v_mov_b32 v140, 0
v_mov_b32 v141, 0
v_mov_b32 v142, 0
v_mov_b32 v143, 0
v_mov_b32 v160, 0
v_mov_b32 v161, 0
v_mov_b32 v162, 0
v_mov_b32 v163, 0
v_mov_b32 v144, 0
v_mov_b32 v145, 0
v_mov_b32 v146, 0
v_mov_b32 v147, 0
v_mov_b32 v148, 0
v_mov_b32 v149, 0
v_mov_b32 v150, 0
v_mov_b32 v151, 0
v_mov_b32 v152, 0
v_mov_b32 v153, 0
v_mov_b32 v154, 0
v_mov_b32 v155, 0
v_mov_b32 v156, 0
v_mov_b32 v157, 0
v_mov_b32 v158, 0
v_mov_b32 v159, 0
v_mov_b32 v164, 0
v_mov_b32 v165, 0
v_mov_b32 v166, 0
v_mov_b32 v167, 0
s_lshl_b32 s34, s23, 14
v_add_u32 v2, s34, v1
v_add_u32 v3, 32768, v2
s_add_u32 s26, s34, 32768
s_lshl_b32 s58, s22, 16
s_lshl_b32 s35, s20, 10
s_add_u32 s58, s58, s35
s_add_u32 s58, s58, 16777216
s_lshl_b32 s34, s22, 11
s_lshl_b32 s35, s20, 5
s_add_u32 s34, s34, s35
s_add_u32 s48, s34, 18874368
s_and_b32 s49, s30, 7
s_lshl_b32 s49, s49, 11
s_add_u32 s49, s49, 131072
s_lshl_b32 s34, s30, 9
s_add_u32 s57, s34, 19398656
s_lshr_b32 s62, s3, 1
s_lshl_b32 s62, s62, 2
s_and_b32 s35, s69, 3
s_add_u32 s62, s62, s35
s_and_b32 s63, s3, 1
s_lshl_b32 s63, s63, 3
s_lshr_b32 s35, s69, 2
s_add_u32 s63, s63, s35
v_lshrrev_b32 v6, 4, v0
v_and_b32 v7, 15, v0
v_lshlrev_b32 v4, 9, v6
v_lshl_add_u32 v172, v7, 4, v4
v_bfe_u32 v4, v0, 4, 1
v_lshlrev_b32 v4, 3, v4
v_bfe_u32 v5, v0, 2, 2
v_add_u32 v4, v4, v5
v_lshlrev_b32 v4, 11, v4
v_lshrrev_b32 v5, 5, v0
v_lshl_add_u32 v4, v5, 6, v4
s_and_b32 s34, s65, 1
v_bfe_u32 v5, v0, 1, 1
v_xor_b32 v5, s34, v5
v_lshl_add_u32 v4, v5, 5, v4
v_and_b32 v5, 1, v0
v_lshl_add_u32 v173, v5, 4, v4
v_lshlrev_b32 v4, 10, v6
v_and_b32 v5, 1, v6
v_lshl_add_u32 v4, v5, 5, v4
v_bfe_u32 v5, v0, 2, 2
v_lshl_add_u32 v4, v5, 6, v4
v_and_b32 v5, 3, v0
v_lshl_add_u32 v4, v5, 3, v4
s_lshl_b32 s34, s23, 14
v_add_u32 v174, s34, v4
v_xor_b32 v175, 32, v174
v_add_u32 v191, 0x10000, v175
s_lshl_b32 s66, s23, 14
s_lshl_b32 s34, s65, 10
s_add_u32 s66, s66, s34
s_lshr_b32 s67, s65, 1
s_lshl_b32 s67, s67, 4
s_and_b32 s34, s65, 1
s_lshl_b32 s34, s34, 2
s_add_u32 s67, s67, s34
s_lshl_b32 s67, s67, 11
s_lshl_b32 s34, s63, 7
s_add_u32 s67, s67, s34
s_lshl_b32 s34, s23, 16
s_add_u32 s67, s67, s34
s_lshl_b32 s68, s62, 6
s_add_u32 s68, s68, s23
s_lshl_b32 s68, s68, 2
s_add_u32 s68, s68, s65
s_lshl_b32 s68, s68, 11
s_add_u32 s68, s68, 20971520
s_lshl_b32 s32, s21, 7
s_lshl_b32 s34, s22, 2
s_add_u32 s32, s32, s34
s_add_u32 s32, s32, 19660800
s_lshr_b32 s33, s62, 1
s_lshl_b32 s33, s33, 7
s_add_u32 s33, s33, 19660800
v_and_b32 v4, 31, v0
v_lshlrev_b32 v179, 2, v4
s_cmp_eq_u32 s20, 0
s_cselect_b32 s28, 3, 63
s_waitcnt vmcnt(0)
v_mov_b32 v4, 1
s_mov_b64 exec, 1
buffer_store_dword v4, off, s[12:15], s95 sc1
s_mov_b64 exec, -1
s_waitcnt lgkmcnt(0)
s_barrier
v_lshlrev_b32 v243, 4, v185
s_lshl_b32 s34, s65, 11
s_add_u32 s34, s34, 81920
v_add_u32 v240, s34, v243
s_lshl_b32 s34, s65, 10
s_add_u32 s34, s34, 90112
v_add_u32 v241, s34, v243
ds_read_b128 v[192:195], v240 offset:0
ds_read_b128 v[196:199], v240 offset:12288
ds_read_b128 v[200:203], v240 offset:24576
ds_read_b128 v[204:207], v240 offset:36864
ds_read_b128 v[208:211], v240 offset:1024
ds_read_b128 v[212:215], v240 offset:13312
ds_read_b128 v[216:219], v240 offset:25600
ds_read_b128 v[220:223], v240 offset:37888
ds_read_b128 v[224:227], v241 offset:0
ds_read_b128 v[228:231], v241 offset:12288
ds_read_b128 v[232:235], v241 offset:24576
ds_read_b128 v[236:239], v241 offset:36864
s_lshl_b32 s34, s22, 3
s_add_u32 s34, s34, s21
s_lshl_b32 s46, s34, 13
s_lshl_b32 s35, s65, 11
s_add_u32 s46, s46, s35
s_add_u32 s46, s46, 16777216
s_lshl_b32 s47, s34, 8
s_lshl_b32 s35, s65, 6
s_add_u32 s47, s47, s35
s_add_u32 s47, s47, 18874368
v_and_b32 v242, 15, v185
v_cmp_eq_u32 vcc, 0, v242
v_lshrrev_b32 v242, 4, v185
v_lshlrev_b32 v242, 4, v242
v_mov_b32 v243, 0x7ffff000
v_cndmask_b32 v242, v243, v242, vcc
s_waitcnt lgkmcnt(0)
v_pk_add_f32 v[192:193], v[192:193], v[196:197]
v_pk_add_f32 v[200:201], v[200:201], v[204:205]
v_pk_add_f32 v[194:195], v[194:195], v[198:199]
v_pk_add_f32 v[202:203], v[202:203], v[206:207]
v_pk_add_f32 v[192:193], v[192:193], v[200:201]
v_pk_add_f32 v[194:195], v[194:195], v[202:203]
v_pk_add_f32 v[208:209], v[208:209], v[212:213]
v_pk_add_f32 v[216:217], v[216:217], v[220:221]
v_pk_add_f32 v[210:211], v[210:211], v[214:215]
v_pk_add_f32 v[218:219], v[218:219], v[222:223]
v_pk_add_f32 v[208:209], v[208:209], v[216:217]
v_pk_add_f32 v[210:211], v[210:211], v[218:219]
v_pk_add_f32 v[224:225], v[224:225], v[228:229]
v_pk_add_f32 v[232:233], v[232:233], v[236:237]
v_pk_add_f32 v[226:227], v[226:227], v[230:231]
v_pk_add_f32 v[234:235], v[234:235], v[238:239]
v_pk_add_f32 v[224:225], v[224:225], v[232:233]
v_pk_add_f32 v[226:227], v[226:227], v[234:235]
s_branch K2_join
K1_epiA:
v_lshrrev_b32 v162, 4, v185
v_bfe_u32 v163, v185, 2, 2
v_lshl_add_u32 v163, v162, 2, v163
v_and_b32 v164, 3, v185
v_lshlrev_b32 v164, 3, v164
v_lshl_add_u32 v163, v163, 6, v164
v_add_u32 v163, 159744, v163
ds_read_b64_tr_b16 v[144:145], v163 offset:0
ds_read_b64_tr_b16 v[146:147], v163 offset:1024
ds_read_b64_tr_b16 v[148:149], v163 offset:32
ds_read_b64_tr_b16 v[150:151], v163 offset:1056
s_lshl_b32 s34, s24, 12
s_add_u32 s34, s34, 131072
v_add_u32 v242, s34, v186
v_cvt_pk_bf16_f32 v112, v32, v33
v_cvt_pk_bf16_f32 v113, v34, v35
v_cvt_pk_bf16_f32 v114, v48, v49
v_cvt_pk_bf16_f32 v115, v50, v51
v_cvt_pk_bf16_f32 v116, v36, v37
v_cvt_pk_bf16_f32 v117, v38, v39
v_cvt_pk_bf16_f32 v118, v52, v53
v_cvt_pk_bf16_f32 v119, v54, v55
v_cvt_pk_bf16_f32 v120, v40, v41
v_cvt_pk_bf16_f32 v121, v42, v43
v_cvt_pk_bf16_f32 v122, v56, v57
v_cvt_pk_bf16_f32 v123, v58, v59
v_cvt_pk_bf16_f32 v124, v44, v45
v_cvt_pk_bf16_f32 v125, v46, v47
v_cvt_pk_bf16_f32 v126, v60, v61
v_cvt_pk_bf16_f32 v127, v62, v63
v_cvt_pk_bf16_f32 v96, v0, v1
v_cvt_pk_bf16_f32 v97, v2, v3
v_cvt_pk_bf16_f32 v98, v16, v17
v_cvt_pk_bf16_f32 v99, v18, v19
v_cvt_pk_bf16_f32 v100, v4, v5
v_cvt_pk_bf16_f32 v101, v6, v7
v_cvt_pk_bf16_f32 v102, v20, v21
v_cvt_pk_bf16_f32 v103, v22, v23
v_cvt_pk_bf16_f32 v104, v8, v9
v_cvt_pk_bf16_f32 v105, v10, v11
v_cvt_pk_bf16_f32 v106, v24, v25
v_cvt_pk_bf16_f32 v107, v26, v27
v_cvt_pk_bf16_f32 v108, v12, v13
v_cvt_pk_bf16_f32 v109, v14, v15
v_cvt_pk_bf16_f32 v110, v28, v29
v_cvt_pk_bf16_f32 v111, v30, v31
ds_write_b128 v242, v[96:99] offset:0
ds_write_b128 v242, v[100:103] offset:256
ds_write_b128 v242, v[104:107] offset:2048
ds_write_b128 v242, v[108:111] offset:2304
v_cvt_pk_bf16_f32 v128, v64, v65
v_cvt_pk_bf16_f32 v129, v66, v67
v_cvt_pk_bf16_f32 v130, v72, v73
v_cvt_pk_bf16_f32 v131, v74, v75
v_cvt_pk_bf16_f32 v132, v68, v69
v_cvt_pk_bf16_f32 v133, v70, v71
v_cvt_pk_bf16_f32 v134, v76, v77
v_cvt_pk_bf16_f32 v135, v78, v79
v_cvt_pk_bf16_f32 v136, v80, v81
v_cvt_pk_bf16_f32 v137, v82, v83
v_cvt_pk_bf16_f32 v138, v88, v89
v_cvt_pk_bf16_f32 v139, v90, v91
v_cvt_pk_bf16_f32 v140, v84, v85
v_cvt_pk_bf16_f32 v141, v86, v87
v_cvt_pk_bf16_f32 v142, v92, v93
v_cvt_pk_bf16_f32 v143, v94, v95
v_mov_b32 v152, 0x3f803f80
v_mov_b32 v153, 0x3f803f80
v_mov_b32 v154, 0x3f803f80
v_mov_b32 v155, 0x3f803f80
v_and_b32 v164, 15, v185
v_lshlrev_b32 v165, 2, v162
v_sub_u32 v164, v164, v165
v_and_b32 v165, 1, v164
v_lshlrev_b32 v165, 4, v165
v_mov_b32 v166, 0x3f80
v_lshlrev_b32 v165, v165, v166
v_lshrrev_b32 v164, 1, v164
v_mov_b32 v166, 0
v_cmp_eq_u32 vcc, 0, v164
v_mov_b32 v156, 0
v_mov_b32 v157, 0
v_cndmask_b32 v158, v166, v165, vcc
v_cmp_eq_u32 vcc, 1, v164
v_mov_b32 v160, 0
v_mov_b32 v161, 0
v_cndmask_b32 v159, v166, v165, vcc
s_waitcnt lgkmcnt(0)
v_mfma_f32_16x16x32_bf16 v[0:3], v[144:147], v[112:115], 0
v_mfma_f32_16x16x32_bf16 v[4:7], v[148:151], v[112:115], 0
v_mfma_f32_16x16x32_bf16 v[8:11], v[144:147], v[116:119], 0
v_mfma_f32_16x16x32_bf16 v[12:15], v[148:151], v[116:119], 0
v_mfma_f32_16x16x32_bf16 v[16:19], v[144:147], v[120:123], 0
v_mfma_f32_16x16x32_bf16 v[20:23], v[148:151], v[120:123], 0
v_mfma_f32_16x16x32_bf16 v[24:27], v[144:147], v[124:127], 0
v_mfma_f32_16x16x32_bf16 v[28:31], v[148:151], v[124:127], 0
s_mov_b32 s60, 0x3fb8aa3b
s_mov_b32 s61, 0x3fb8aa3b
s_mov_b32 s66, 0xbfb8aa3b
s_mov_b32 s67, 0xbfb8aa3b
s_nop 3
v_max3_f32 v162, v0, v1, v2
v_max3_f32 v166, -v0, -v1, -v2
v_max3_f32 v163, v8, v9, v10
v_max3_f32 v167, -v8, -v9, -v10
v_max3_f32 v164, v16, v17, v18
v_max3_f32 v168, -v16, -v17, -v18
v_max3_f32 v165, v24, v25, v26
v_max3_f32 v169, -v24, -v25, -v26
v_max3_f32 v162, v162, v3, v4
v_max3_f32 v166, v166, -v3, -v4
v_max3_f32 v163, v163, v11, v12
v_max3_f32 v167, v167, -v11, -v12
v_max3_f32 v164, v164, v19, v20
v_max3_f32 v168, v168, -v19, -v20
v_max3_f32 v165, v165, v27, v28
v_max3_f32 v169, v169, -v27, -v28
v_max3_f32 v162, v162, v5, v6
v_max3_f32 v166, v166, -v5, -v6
v_max3_f32 v163, v163, v13, v14
v_max3_f32 v167, v167, -v13, -v14
v_max3_f32 v164, v164, v21, v22
v_max3_f32 v168, v168, -v21, -v22
v_max3_f32 v165, v165, v29, v30
v_max3_f32 v169, v169, -v29, -v30
v_max_f32 v162, v162, v7
v_max_f32_e64 v166, v166, -v7
v_max_f32 v163, v163, v15
v_max_f32_e64 v167, v167, -v15
v_max_f32 v164, v164, v23
v_max_f32_e64 v168, v168, -v23
v_max_f32 v165, v165, v31
v_max_f32_e64 v169, v169, -v31
s_nop 1
v_permlane32_swap_b32 v162, v166
v_permlane32_swap_b32 v163, v167
v_permlane32_swap_b32 v164, v168
v_permlane32_swap_b32 v165, v169
v_max_f32 v162, v162, v166
v_max_f32 v163, v163, v167
v_max_f32 v164, v164, v168
v_max_f32 v165, v165, v169
s_nop 0
v_permlane16_swap_b32 v162, v163
v_permlane16_swap_b32 v164, v165
v_max_f32 v162, v162, v163
v_max_f32 v164, v164, v165
v_mov_b32 v163, v162
v_mov_b32 v165, v164
s_nop 0
v_permlane16_swap_b32 v162, v163
v_permlane16_swap_b32 v164, v165
v_mov_b32 v166, v162
v_mov_b32 v167, v163
v_mov_b32 v168, v164
v_mov_b32 v169, v165
s_nop 0
v_permlane32_swap_b32 v162, v166
v_permlane32_swap_b32 v163, v167
v_permlane32_swap_b32 v164, v168
v_permlane32_swap_b32 v165, v169
v_mul_f32 v220, s66, v162
v_mul_f32 v222, s66, v166
v_mul_f32 v224, s66, v163
v_mul_f32 v226, s66, v167
v_mul_f32 v228, s66, v164
v_mul_f32 v230, s66, v168
v_mul_f32 v232, s66, v165
v_mul_f32 v234, s66, v169
v_pk_fma_f32 v[32:33], v[0:1], s[60:61], v[220:221] op_sel_hi:[1,1,0]
v_pk_fma_f32 v[34:35], v[2:3], s[60:61], v[220:221] op_sel_hi:[1,1,0]
v_pk_fma_f32 v[36:37], v[4:5], s[60:61], v[220:221] op_sel_hi:[1,1,0]
v_pk_fma_f32 v[38:39], v[6:7], s[60:61], v[220:221] op_sel_hi:[1,1,0]
v_pk_fma_f32 v[40:41], v[8:9], s[60:61], v[224:225] op_sel_hi:[1,1,0]
v_pk_fma_f32 v[42:43], v[10:11], s[60:61], v[224:225] op_sel_hi:[1,1,0]
v_pk_fma_f32 v[44:45], v[12:13], s[60:61], v[224:225] op_sel_hi:[1,1,0]
v_pk_fma_f32 v[46:47], v[14:15], s[60:61], v[224:225] op_sel_hi:[1,1,0]
v_pk_fma_f32 v[48:49], v[16:17], s[60:61], v[228:229] op_sel_hi:[1,1,0]
v_pk_fma_f32 v[50:51], v[18:19], s[60:61], v[228:229] op_sel_hi:[1,1,0]
v_pk_fma_f32 v[52:53], v[20:21], s[60:61], v[228:229] op_sel_hi:[1,1,0]
v_pk_fma_f32 v[54:55], v[22:23], s[60:61], v[228:229] op_sel_hi:[1,1,0]
v_pk_fma_f32 v[56:57], v[24:25], s[60:61], v[232:233] op_sel_hi:[1,1,0]
v_pk_fma_f32 v[58:59], v[26:27], s[60:61], v[232:233] op_sel_hi:[1,1,0]
v_pk_fma_f32 v[60:61], v[28:29], s[60:61], v[232:233] op_sel_hi:[1,1,0]
v_pk_fma_f32 v[62:63], v[30:31], s[60:61], v[232:233] op_sel_hi:[1,1,0]
v_pk_fma_f32 v[64:65], v[0:1], s[66:67], v[222:223] op_sel_hi:[1,1,0]
v_pk_fma_f32 v[66:67], v[2:3], s[66:67], v[222:223] op_sel_hi:[1,1,0]
v_pk_fma_f32 v[68:69], v[4:5], s[66:67], v[222:223] op_sel_hi:[1,1,0]
v_pk_fma_f32 v[70:71], v[6:7], s[66:67], v[222:223] op_sel_hi:[1,1,0]
v_pk_fma_f32 v[72:73], v[8:9], s[66:67], v[226:227] op_sel_hi:[1,1,0]
v_pk_fma_f32 v[74:75], v[10:11], s[66:67], v[226:227] op_sel_hi:[1,1,0]
v_pk_fma_f32 v[76:77], v[12:13], s[66:67], v[226:227] op_sel_hi:[1,1,0]
v_pk_fma_f32 v[78:79], v[14:15], s[66:67], v[226:227] op_sel_hi:[1,1,0]
v_pk_fma_f32 v[80:81], v[16:17], s[66:67], v[230:231] op_sel_hi:[1,1,0]
v_pk_fma_f32 v[82:83], v[18:19], s[66:67], v[230:231] op_sel_hi:[1,1,0]
v_pk_fma_f32 v[84:85], v[20:21], s[66:67], v[230:231] op_sel_hi:[1,1,0]
v_pk_fma_f32 v[86:87], v[22:23], s[66:67], v[230:231] op_sel_hi:[1,1,0]
v_pk_fma_f32 v[88:89], v[24:25], s[66:67], v[234:235] op_sel_hi:[1,1,0]
v_pk_fma_f32 v[90:91], v[26:27], s[66:67], v[234:235] op_sel_hi:[1,1,0]
v_pk_fma_f32 v[92:93], v[28:29], s[66:67], v[234:235] op_sel_hi:[1,1,0]
v_pk_fma_f32 v[94:95], v[30:31], s[66:67], v[234:235] op_sel_hi:[1,1,0]
v_exp_f32 v32, v32
v_exp_f32 v33, v33
v_exp_f32 v34, v34
v_exp_f32 v35, v35
v_exp_f32 v36, v36
v_exp_f32 v37, v37
v_exp_f32 v38, v38
v_exp_f32 v39, v39
v_exp_f32 v40, v40
v_exp_f32 v41, v41
v_exp_f32 v42, v42
v_exp_f32 v43, v43
v_exp_f32 v44, v44
v_exp_f32 v45, v45
v_exp_f32 v46, v46
v_exp_f32 v47, v47
v_exp_f32 v48, v48
v_exp_f32 v49, v49
v_exp_f32 v50, v50
v_exp_f32 v51, v51
v_exp_f32 v52, v52
v_exp_f32 v53, v53
v_exp_f32 v54, v54
v_exp_f32 v55, v55
v_exp_f32 v56, v56
v_exp_f32 v57, v57
v_exp_f32 v58, v58
v_exp_f32 v59, v59
v_exp_f32 v60, v60
v_exp_f32 v61, v61
v_exp_f32 v62, v62
v_exp_f32 v63, v63
v_exp_f32 v64, v64
v_exp_f32 v65, v65
v_exp_f32 v66, v66
v_exp_f32 v67, v67
v_exp_f32 v68, v68
v_exp_f32 v69, v69
v_exp_f32 v70, v70
v_exp_f32 v71, v71
v_exp_f32 v72, v72
v_exp_f32 v73, v73
v_exp_f32 v74, v74
v_exp_f32 v75, v75
v_exp_f32 v76, v76
v_exp_f32 v77, v77
v_exp_f32 v78, v78
v_exp_f32 v79, v79
v_exp_f32 v80, v80
v_exp_f32 v81, v81
v_exp_f32 v82, v82
v_exp_f32 v83, v83
v_exp_f32 v84, v84
v_exp_f32 v85, v85
v_exp_f32 v86, v86
v_exp_f32 v87, v87
v_exp_f32 v88, v88
v_exp_f32 v89, v89
v_exp_f32 v90, v90
v_exp_f32 v91, v91
v_exp_f32 v92, v92
v_exp_f32 v93, v93
v_exp_f32 v94, v94
v_exp_f32 v95, v95
s_nop 0
v_cvt_pk_bf16_f32 v0, v32, v33
v_cvt_pk_bf16_f32 v1, v34, v35
v_cvt_pk_bf16_f32 v2, v36, v37
v_cvt_pk_bf16_f32 v3, v38, v39
v_cvt_pk_bf16_f32 v4, v40, v41
v_cvt_pk_bf16_f32 v5, v42, v43
v_cvt_pk_bf16_f32 v6, v44, v45
v_cvt_pk_bf16_f32 v7, v46, v47
v_cvt_pk_bf16_f32 v8, v48, v49
v_cvt_pk_bf16_f32 v9, v50, v51
v_cvt_pk_bf16_f32 v10, v52, v53
v_cvt_pk_bf16_f32 v11, v54, v55
v_cvt_pk_bf16_f32 v12, v56, v57
v_cvt_pk_bf16_f32 v13, v58, v59
v_cvt_pk_bf16_f32 v14, v60, v61
v_cvt_pk_bf16_f32 v15, v62, v63
v_cvt_pk_bf16_f32 v16, v64, v65
v_cvt_pk_bf16_f32 v17, v66, v67
v_cvt_pk_bf16_f32 v18, v68, v69
v_cvt_pk_bf16_f32 v19, v70, v71
v_cvt_pk_bf16_f32 v20, v72, v73
v_cvt_pk_bf16_f32 v21, v74, v75
v_cvt_pk_bf16_f32 v22, v76, v77
v_cvt_pk_bf16_f32 v23, v78, v79
v_cvt_pk_bf16_f32 v24, v80, v81
v_cvt_pk_bf16_f32 v25, v82, v83
v_cvt_pk_bf16_f32 v26, v84, v85
v_cvt_pk_bf16_f32 v27, v86, v87
v_cvt_pk_bf16_f32 v28, v88, v89
v_cvt_pk_bf16_f32 v29, v90, v91
v_cvt_pk_bf16_f32 v30, v92, v93
v_cvt_pk_bf16_f32 v31, v94, v95
s_nop 0
v_mfma_f32_16x16x32_bf16 v[188:191], v[152:155], v[0:3], 0
v_mfma_f32_16x16x32_bf16 v[192:195], v[152:155], v[4:7], 0
v_mfma_f32_16x16x32_bf16 v[196:199], v[152:155], v[8:11], 0
v_mfma_f32_16x16x32_bf16 v[200:203], v[152:155], v[12:15], 0
v_mfma_f32_16x16x32_bf16 v[204:207], v[152:155], v[16:19], 0
v_mfma_f32_16x16x32_bf16 v[208:211], v[152:155], v[20:23], 0
v_mfma_f32_16x16x32_bf16 v[212:215], v[152:155], v[24:27], 0
v_mfma_f32_16x16x32_bf16 v[216:219], v[152:155], v[28:31], 0
s_nop 0
v_rcp_f32 v220, v188
v_rcp_f32 v224, v192
v_rcp_f32 v228, v196
v_rcp_f32 v232, v200
v_rcp_f32 v222, v204
v_rcp_f32 v226, v208
v_rcp_f32 v230, v212
s_nop 6
v_rcp_f32 v234, v216
s_nop 0
v_pk_mul_f32 v[32:33], v[32:33], v[220:221] op_sel_hi:[1,0]
v_pk_mul_f32 v[34:35], v[34:35], v[220:221] op_sel_hi:[1,0]
v_pk_mul_f32 v[36:37], v[36:37], v[220:221] op_sel_hi:[1,0]
v_pk_mul_f32 v[38:39], v[38:39], v[220:221] op_sel_hi:[1,0]
v_pk_mul_f32 v[40:41], v[40:41], v[224:225] op_sel_hi:[1,0]
v_pk_mul_f32 v[42:43], v[42:43], v[224:225] op_sel_hi:[1,0]
v_pk_mul_f32 v[44:45], v[44:45], v[224:225] op_sel_hi:[1,0]
v_pk_mul_f32 v[46:47], v[46:47], v[224:225] op_sel_hi:[1,0]
v_pk_mul_f32 v[48:49], v[48:49], v[228:229] op_sel_hi:[1,0]
v_pk_mul_f32 v[50:51], v[50:51], v[228:229] op_sel_hi:[1,0]
v_pk_mul_f32 v[52:53], v[52:53], v[228:229] op_sel_hi:[1,0]
v_pk_mul_f32 v[54:55], v[54:55], v[228:229] op_sel_hi:[1,0]
v_pk_mul_f32 v[56:57], v[56:57], v[232:233] op_sel_hi:[1,0]
v_pk_mul_f32 v[58:59], v[58:59], v[232:233] op_sel_hi:[1,0]
v_pk_mul_f32 v[60:61], v[60:61], v[232:233] op_sel_hi:[1,0]
v_pk_mul_f32 v[62:63], v[62:63], v[232:233] op_sel_hi:[1,0]
v_pk_mul_f32 v[64:65], v[64:65], v[222:223] op_sel_hi:[1,0]
v_pk_mul_f32 v[66:67], v[66:67], v[222:223] op_sel_hi:[1,0]
v_pk_mul_f32 v[68:69], v[68:69], v[222:223] op_sel_hi:[1,0]
v_pk_mul_f32 v[70:71], v[70:71], v[222:223] op_sel_hi:[1,0]
v_pk_mul_f32 v[72:73], v[72:73], v[226:227] op_sel_hi:[1,0]
v_pk_mul_f32 v[74:75], v[74:75], v[226:227] op_sel_hi:[1,0]
v_pk_mul_f32 v[76:77], v[76:77], v[226:227] op_sel_hi:[1,0]
v_pk_mul_f32 v[78:79], v[78:79], v[226:227] op_sel_hi:[1,0]
v_pk_mul_f32 v[80:81], v[80:81], v[230:231] op_sel_hi:[1,0]
v_pk_mul_f32 v[82:83], v[82:83], v[230:231] op_sel_hi:[1,0]
v_pk_mul_f32 v[84:85], v[84:85], v[230:231] op_sel_hi:[1,0]
v_pk_mul_f32 v[86:87], v[86:87], v[230:231] op_sel_hi:[1,0]
v_pk_mul_f32 v[88:89], v[88:89], v[234:235] op_sel_hi:[1,0]
v_pk_mul_f32 v[90:91], v[90:91], v[234:235] op_sel_hi:[1,0]
v_pk_mul_f32 v[92:93], v[92:93], v[234:235] op_sel_hi:[1,0]
v_pk_mul_f32 v[94:95], v[94:95], v[234:235] op_sel_hi:[1,0]
v_cvt_pk_bf16_f32 v0, v32, v33
v_cvt_pk_bf16_f32 v1, v34, v35
v_cvt_pk_bf16_f32 v2, v36, v37
v_cvt_pk_bf16_f32 v3, v38, v39
v_cvt_pk_bf16_f32 v4, v40, v41
v_cvt_pk_bf16_f32 v5, v42, v43
v_cvt_pk_bf16_f32 v6, v44, v45
v_cvt_pk_bf16_f32 v7, v46, v47
v_cvt_pk_bf16_f32 v8, v48, v49
v_cvt_pk_bf16_f32 v9, v50, v51
v_cvt_pk_bf16_f32 v10, v52, v53
v_cvt_pk_bf16_f32 v11, v54, v55
v_cvt_pk_bf16_f32 v12, v56, v57
v_cvt_pk_bf16_f32 v13, v58, v59
v_cvt_pk_bf16_f32 v14, v60, v61
v_cvt_pk_bf16_f32 v15, v62, v63
v_cvt_pk_bf16_f32 v16, v64, v65
v_cvt_pk_bf16_f32 v17, v66, v67
v_cvt_pk_bf16_f32 v18, v68, v69
v_cvt_pk_bf16_f32 v19, v70, v71
v_cvt_pk_bf16_f32 v20, v72, v73
v_cvt_pk_bf16_f32 v21, v74, v75
v_cvt_pk_bf16_f32 v22, v76, v77
v_cvt_pk_bf16_f32 v23, v78, v79
v_cvt_pk_bf16_f32 v24, v80, v81
v_cvt_pk_bf16_f32 v25, v82, v83
v_cvt_pk_bf16_f32 v26, v84, v85
v_cvt_pk_bf16_f32 v27, v86, v87
v_cvt_pk_bf16_f32 v28, v88, v89
v_cvt_pk_bf16_f32 v29, v90, v91
v_cvt_pk_bf16_f32 v30, v92, v93
v_cvt_pk_bf16_f32 v31, v94, v95
s_nop 0
v_mfma_f32_16x16x32_bf16 v[32:35], v[0:3], v[158:161], 0
v_mfma_f32_16x16x32_bf16 v[36:39], v[0:3], v[156:159], 0
v_mfma_f32_16x16x32_bf16 v[40:43], v[16:19], v[158:161], 0
v_mfma_f32_16x16x32_bf16 v[44:47], v[16:19], v[156:159], 0
v_mfma_f32_16x16x32_bf16 v[48:51], v[4:7], v[158:161], 0
v_mfma_f32_16x16x32_bf16 v[52:55], v[4:7], v[156:159], 0
v_mfma_f32_16x16x32_bf16 v[56:59], v[20:23], v[158:161], 0
v_mfma_f32_16x16x32_bf16 v[60:63], v[20:23], v[156:159], 0
v_mfma_f32_16x16x32_bf16 v[64:67], v[8:11], v[158:161], 0
v_mfma_f32_16x16x32_bf16 v[68:71], v[8:11], v[156:159], 0
v_mfma_f32_16x16x32_bf16 v[72:75], v[24:27], v[158:161], 0
v_mfma_f32_16x16x32_bf16 v[76:79], v[24:27], v[156:159], 0
v_mfma_f32_16x16x32_bf16 v[80:83], v[12:15], v[158:161], 0
v_mfma_f32_16x16x32_bf16 v[84:87], v[12:15], v[156:159], 0
v_mfma_f32_16x16x32_bf16 v[88:91], v[28:31], v[158:161], 0
v_mfma_f32_16x16x32_bf16 v[92:95], v[28:31], v[156:159], 0
v_cvt_pk_bf16_f32 v0, v32, v33
v_cvt_pk_bf16_f32 v1, v34, v35
v_cvt_pk_bf16_f32 v2, v48, v49
v_cvt_pk_bf16_f32 v3, v50, v51
v_cvt_pk_bf16_f32 v4, v36, v37
v_cvt_pk_bf16_f32 v5, v38, v39
v_cvt_pk_bf16_f32 v6, v52, v53
v_cvt_pk_bf16_f32 v7, v54, v55
v_cvt_pk_bf16_f32 v8, v40, v41
v_cvt_pk_bf16_f32 v9, v42, v43
v_cvt_pk_bf16_f32 v10, v56, v57
v_cvt_pk_bf16_f32 v11, v58, v59
v_cvt_pk_bf16_f32 v12, v44, v45
v_cvt_pk_bf16_f32 v13, v46, v47
v_cvt_pk_bf16_f32 v14, v60, v61
v_cvt_pk_bf16_f32 v15, v62, v63
s_nop 3
v_cvt_pk_bf16_f32 v16, v64, v65
v_cvt_pk_bf16_f32 v17, v66, v67
v_cvt_pk_bf16_f32 v18, v80, v81
v_cvt_pk_bf16_f32 v19, v82, v83
v_cvt_pk_bf16_f32 v20, v68, v69
v_cvt_pk_bf16_f32 v21, v70, v71
v_cvt_pk_bf16_f32 v22, v84, v85
v_cvt_pk_bf16_f32 v23, v86, v87
v_cvt_pk_bf16_f32 v24, v72, v73
v_cvt_pk_bf16_f32 v25, v74, v75
v_cvt_pk_bf16_f32 v26, v88, v89
v_cvt_pk_bf16_f32 v27, v90, v91
v_cvt_pk_bf16_f32 v28, v76, v77
v_cvt_pk_bf16_f32 v29, v78, v79
v_cvt_pk_bf16_f32 v30, v92, v93
v_cvt_pk_bf16_f32 v31, v94, v95
s_nop 0
v_mfma_f32_16x16x32_bf16 v[188:191], v[0:3], v[128:131], 0
v_mfma_f32_16x16x32_bf16 v[192:195], v[0:3], v[132:135], 0
v_mfma_f32_16x16x32_bf16 v[220:223], v[0:3], v[152:155], 0
v_mfma_f32_16x16x32_bf16 v[196:199], v[4:7], v[128:131], 0
v_mfma_f32_16x16x32_bf16 v[200:203], v[4:7], v[132:135], 0
v_mfma_f32_16x16x32_bf16 v[224:227], v[4:7], v[152:155], 0
v_mfma_f32_16x16x32_bf16 v[204:207], v[8:11], v[128:131], 0
v_mfma_f32_16x16x32_bf16 v[208:211], v[8:11], v[132:135], 0
v_mfma_f32_16x16x32_bf16 v[228:231], v[8:11], v[152:155], 0
v_mfma_f32_16x16x32_bf16 v[212:215], v[12:15], v[128:131], 0
v_mfma_f32_16x16x32_bf16 v[216:219], v[12:15], v[132:135], 0
v_mfma_f32_16x16x32_bf16 v[232:235], v[12:15], v[152:155], 0
v_mfma_f32_16x16x32_bf16 v[188:191], v[16:19], v[136:139], v[188:191]
v_mfma_f32_16x16x32_bf16 v[192:195], v[16:19], v[140:143], v[192:195]
v_mfma_f32_16x16x32_bf16 v[220:223], v[16:19], v[152:155], v[220:223]
v_mfma_f32_16x16x32_bf16 v[196:199], v[20:23], v[136:139], v[196:199]
v_mfma_f32_16x16x32_bf16 v[200:203], v[20:23], v[140:143], v[200:203]
v_mfma_f32_16x16x32_bf16 v[224:227], v[20:23], v[152:155], v[224:227]
v_mfma_f32_16x16x32_bf16 v[204:207], v[24:27], v[136:139], v[204:207]
v_mfma_f32_16x16x32_bf16 v[208:211], v[24:27], v[140:143], v[208:211]
v_mfma_f32_16x16x32_bf16 v[228:231], v[24:27], v[152:155], v[228:231]
v_mfma_f32_16x16x32_bf16 v[212:215], v[28:31], v[136:139], v[212:215]
v_mfma_f32_16x16x32_bf16 v[216:219], v[28:31], v[140:143], v[216:219]
v_mfma_f32_16x16x32_bf16 v[232:235], v[28:31], v[152:155], v[232:235]
s_mul_i32 s34, s24, 12288
s_add_u32 s34, s34, 81920
v_lshlrev_b32 v0, 4, v185
v_add_u32 v1, s34, v0
s_nop 4
ds_write_b128 v1, v[188:191] offset:0
ds_write_b128 v1, v[192:195] offset:1024
ds_write_b128 v1, v[196:199] offset:2048
ds_write_b128 v1, v[200:203] offset:3072
ds_write_b128 v1, v[204:207] offset:4096
ds_write_b128 v1, v[208:211] offset:5120
ds_write_b128 v1, v[212:215] offset:6144
ds_write_b128 v1, v[216:219] offset:7168
ds_write_b128 v1, v[220:223] offset:8192
ds_write_b128 v1, v[224:227] offset:9216
ds_write_b128 v1, v[228:231] offset:10240
ds_write_b128 v1, v[232:235] offset:11264
s_waitcnt lgkmcnt(0)
s_barrier
s_and_b32 s3, s2, 7
s_lshr_b32 s69, s2, 3
v_mov_b32 v0, v185
v_lshlrev_b32 v1, 4, v0
s_and_b32 s65, s20, 3
s_lshl_b32 s34, s65, 1
s_lshl_b32 s30, s21, 3
s_add_u32 s30, s30, s34
s_add_u32 s30, s30, s23
s_add_u32 s35, s21, 1
s_and_b32 s35, s35, 7
s_lshl_b32 s24, s35, 15
s_lshl_b32 s34, s20, 12
s_add_u32 s24, s24, s34
s_add_u32 s25, s34, 32768
s_lshl_b32 s34, s22, 18
v_add_u32 v190, s34, v1
s_lshl_b32 s100, s22, 5
s_lshr_b32 s34, s20, 1
s_add_u32 s100, s100, s34
s_lshl_b32 s100, s100, 2
s_add_u32 s100, s100, 19664896
s_lshl_b32 s35, s35, 12
s_add_u32 s101, s100, s35
s_add_u32 s35, s21, 2
s_and_b32 s35, s35, 7
s_lshl_b32 s35, s35, 12
s_add_u32 s64, s100, s35
v_and_b32 v4, 31, v0
v_and_b32 v5, 7, v4
v_lshlrev_b32 v5, 12, v5
v_add_u32 v5, s100, v5
v_add_u32 v6, 16, v5
v_cmp_gt_u32 vcc, 8, v4
s_and_b32 s34, s30, 7
s_lshl_b32 s34, s34, 9
v_cndmask_b32 v5, v5, v6, vcc
s_lshl_b32 s35, s21, 12
s_add_u32 s34, s34, s35
s_add_u32 s34, s34, 19664896
v_subrev_u32 v6, 8, v4
v_bfe_u32 v7, v6, 2, 2
v_lshlrev_b32 v7, 7, v7
v_add_u32 v7, s34, v7
v_cmp_gt_u32 vcc, 16, v6
v_and_b32 v6, 3, v6
v_lshl_add_u32 v7, v6, 2, v7
v_cndmask_b32 v188, v5, v7, vcc
s_mov_b32 s4, s42
s_mov_b32 s5, s43
s_mov_b32 s6, 2097152
s_mov_b32 s7, 0x20000
s_mov_b32 s8, s44
s_mov_b32 s9, s45
s_mov_b32 s10, 2097152
s_mov_b32 s11, 0x20000
s_mov_b32 s16, s96
s_mov_b32 s17, s97
s_mov_b32 s18, 4194304
s_mov_b32 s19, 0x20000
s_lshr_b32 s34, s30, 2
s_lshl_b32 s34, s34, 6
s_add_u32 s34, s34, s22
s_lshl_b32 s34, s34, 2
s_and_b32 s35, s30, 3
s_add_u32 s34, s34, s35
s_lshl_b32 s29, s34, 11
s_add_u32 s29, s29, 20971520
v_and_b32 v4, 7, v0
v_mov_b32 v5, 0x3f803f80
v_mov_b32 v6, 0
v_cmp_eq_u32 vcc, 0, v4
v_cmp_eq_u32 s[34:35], 4, v4
v_mov_b32 v189, 0xdddddddd
v_cndmask_b32 v168, v6, v5, vcc
v_cndmask_b32 v169, v6, v5, vcc
v_cndmask_b32 v170, v6, v5, s[34:35]
v_cndmask_b32 v171, v6, v5, s[34:35]
v_mov_b32 v128, 0
v_mov_b32 v129, 0
v_mov_b32 v130, 0
v_mov_b32 v131, 0
v_mov_b32 v132, 0
v_mov_b32 v133, 0
v_mov_b32 v134, 0
v_mov_b32 v135, 0
v_mov_b32 v136, 0
v_mov_b32 v137, 0
v_mov_b32 v138, 0
v_mov_b32 v139, 0
v_mov_b32 v140, 0
v_mov_b32 v141, 0
v_mov_b32 v142, 0
v_mov_b32 v143, 0
v_mov_b32 v160, 0
v_mov_b32 v161, 0
v_mov_b32 v162, 0
v_mov_b32 v163, 0
v_mov_b32 v144, 0
v_mov_b32 v145, 0
v_mov_b32 v146, 0
v_mov_b32 v147, 0
v_mov_b32 v148, 0
v_mov_b32 v149, 0
v_mov_b32 v150, 0
v_mov_b32 v151, 0
v_mov_b32 v152, 0
v_mov_b32 v153, 0
v_mov_b32 v154, 0
v_mov_b32 v155, 0
v_mov_b32 v156, 0
v_mov_b32 v157, 0
v_mov_b32 v158, 0
v_mov_b32 v159, 0
v_mov_b32 v164, 0
v_mov_b32 v165, 0
v_mov_b32 v166, 0
v_mov_b32 v167, 0
s_lshl_b32 s34, s23, 14
v_add_u32 v2, s34, v1
v_add_u32 v3, 32768, v2
s_add_u32 s26, s34, 32768
s_lshl_b32 s58, s22, 16
s_lshl_b32 s35, s20, 10
s_add_u32 s58, s58, s35
s_add_u32 s58, s58, 16777216
s_lshl_b32 s34, s22, 11
s_lshl_b32 s35, s20, 5
s_add_u32 s34, s34, s35
s_add_u32 s48, s34, 18874368
s_and_b32 s49, s30, 7
s_lshl_b32 s49, s49, 11
s_add_u32 s49, s49, 131072
s_lshl_b32 s34, s30, 9
s_add_u32 s57, s34, 19398656
s_lshr_b32 s62, s3, 1
s_lshl_b32 s62, s62, 2
s_and_b32 s35, s69, 3
s_add_u32 s62, s62, s35
s_and_b32 s63, s3, 1
s_lshl_b32 s63, s63, 3
s_lshr_b32 s35, s69, 2
s_add_u32 s63, s63, s35
v_lshrrev_b32 v6, 4, v0
v_and_b32 v7, 15, v0
v_lshlrev_b32 v4, 9, v6
v_lshl_add_u32 v172, v7, 4, v4
v_bfe_u32 v4, v0, 4, 1
v_lshlrev_b32 v4, 3, v4
v_bfe_u32 v5, v0, 2, 2
v_add_u32 v4, v4, v5
v_lshlrev_b32 v4, 11, v4
v_lshrrev_b32 v5, 5, v0
v_lshl_add_u32 v4, v5, 6, v4
s_and_b32 s34, s65, 1
v_bfe_u32 v5, v0, 1, 1
v_xor_b32 v5, s34, v5
v_lshl_add_u32 v4, v5, 5, v4
v_and_b32 v5, 1, v0
v_lshl_add_u32 v173, v5, 4, v4
v_lshlrev_b32 v4, 10, v6
v_and_b32 v5, 1, v6
v_lshl_add_u32 v4, v5, 5, v4
v_bfe_u32 v5, v0, 2, 2
v_lshl_add_u32 v4, v5, 6, v4
v_and_b32 v5, 3, v0
v_lshl_add_u32 v4, v5, 3, v4
s_lshl_b32 s34, s23, 14
v_add_u32 v174, s34, v4
v_xor_b32 v175, 32, v174
v_add_u32 v191, 0x10000, v175
s_lshl_b32 s66, s23, 14
s_lshl_b32 s34, s65, 10
s_add_u32 s66, s66, s34
s_lshr_b32 s67, s65, 1
s_lshl_b32 s67, s67, 4
s_and_b32 s34, s65, 1
s_lshl_b32 s34, s34, 2
s_add_u32 s67, s67, s34
s_lshl_b32 s67, s67, 11
s_lshl_b32 s34, s63, 7
s_add_u32 s67, s67, s34
s_lshl_b32 s34, s23, 16
s_add_u32 s67, s67, s34
s_lshl_b32 s68, s62, 6
s_add_u32 s68, s68, s23
s_lshl_b32 s68, s68, 2
s_add_u32 s68, s68, s65
s_lshl_b32 s68, s68, 11
s_add_u32 s68, s68, 20971520
s_lshl_b32 s32, s21, 7
s_lshl_b32 s34, s22, 2
s_add_u32 s32, s32, s34
s_add_u32 s32, s32, 19660800
s_lshr_b32 s33, s62, 1
s_lshl_b32 s33, s33, 7
s_add_u32 s33, s33, 19660800
v_and_b32 v4, 31, v0
v_lshlrev_b32 v179, 2, v4
s_cmp_eq_u32 s20, 0
s_cselect_b32 s28, 3, 63
K2_join:
s_lshl_b32 s34, s65, 12
s_add_u32 s34, s34, 65536
v_add_u32 v4, s34, v1
ds_read_b128 v[8:11], v4 offset:0
ds_read_b128 v[12:15], v4 offset:1024
ds_read_b128 v[16:19], v4 offset:2048
ds_read_b128 v[20:23], v4 offset:3072
ds_read_b128 v[64:67], v1 offset:0
ds_read_b128 v[68:71], v1 offset:1024
ds_read_b128 v[56:59], v2 offset:0
ds_read_b128 v[60:63], v2 offset:1024
ds_read_b128 v[72:75], v2 offset:2048
ds_read_b128 v[76:79], v2 offset:3072
buffer_load_dword v178, off, s[12:15], s101 sc1
s_cmp_eq_u32 s23, 0
s_cbranch_scc1 K2_nokvp0
buffer_store_dwordx4 v[192:195], v186, s[12:15], s46 offen sc1
buffer_store_dwordx4 v[208:211], v186, s[12:15], s46 offen offset:256 sc1
buffer_store_dwordx4 v[224:227], v242, s[12:15], s47 offen sc1
K2_nokvp0:
s_waitcnt lgkmcnt(4)
v_mfma_f32_32x32x16_bf16 v[88:103], v[64:67], v[8:11], 0
v_mfma_f32_32x32x16_bf16 v[88:103], v[68:71], v[12:15], v[88:103]
v_mfma_f32_32x32x16_bf16 v[104:119], v[64:67], v[16:19], 0
v_mfma_f32_32x32x16_bf16 v[104:119], v[68:71], v[20:23], v[104:119]
s_nop 7
s_nop 3
v_max3_f32 v4, v88, v89, v90
v_max3_f32 v4, v4, v91, v92
v_max3_f32 v4, v4, v93, v94
v_max3_f32 v4, v4, v95, v96
v_max3_f32 v4, v4, v97, v98
v_max3_f32 v4, v4, v99, v100
v_max3_f32 v4, v4, v101, v102
v_max_f32 v4, v4, v103
v_max3_f32 v5, v104, v105, v106
v_max3_f32 v5, v5, v107, v108
v_max3_f32 v5, v5, v109, v110
v_max3_f32 v5, v5, v111, v112
v_max3_f32 v5, v5, v113, v114
v_max3_f32 v5, v5, v115, v116
v_max3_f32 v5, v5, v117, v118
v_max_f32 v5, v5, v119
v_mov_b32 v6, v4
v_mov_b32 v7, v5
s_nop 0
v_permlane32_swap_b32 v4, v6
v_permlane32_swap_b32 v5, v7
v_max_f32 v4, v4, v6
v_max_f32 v5, v5, v7
s_mov_b32 s34, 0xc2a00000
v_sub_f32 v4, s34, v4
v_sub_f32 v5, s34, v5
v_mov_b32 v24, v4
v_mov_b32 v25, v4
v_mov_b32 v26, v4
v_mov_b32 v27, v4
v_mov_b32 v28, v4
v_mov_b32 v29, v4
v_mov_b32 v30, v4
v_mov_b32 v31, v4
v_mov_b32 v32, v4
v_mov_b32 v33, v4
v_mov_b32 v34, v4
v_mov_b32 v35, v4
v_mov_b32 v36, v4
v_mov_b32 v37, v4
v_mov_b32 v38, v4
v_mov_b32 v39, v4
s_waitcnt lgkmcnt(0)
s_nop 0
v_mfma_f32_32x32x16_bf16 v[88:103], v[56:59], v[8:11], v[24:39]
v_mfma_f32_32x32x16_bf16 v[88:103], v[60:63], v[12:15], v[88:103]
v_mov_b32 v40, v5
v_mov_b32 v41, v5
v_mov_b32 v42, v5
v_mov_b32 v43, v5
v_mov_b32 v44, v5
v_mov_b32 v45, v5
v_mov_b32 v46, v5
v_mov_b32 v47, v5
v_mov_b32 v48, v5
v_mov_b32 v49, v5
v_mov_b32 v50, v5
v_mov_b32 v51, v5
v_mov_b32 v52, v5
v_mov_b32 v53, v5
v_mov_b32 v54, v5
v_mov_b32 v55, v5
s_nop 0
s_waitcnt lgkmcnt(0)
v_exp_f32 v88, v88
v_exp_f32 v89, v89
ds_read_b128 v[64:67], v2 offset:4096
ds_read_b128 v[68:71], v2 offset:5120
v_exp_f32 v90, v90
v_exp_f32 v91, v91
v_exp_f32 v92, v92
v_mfma_f32_32x32x16_bf16 v[104:119], v[56:59], v[16:19], v[40:55]
v_exp_f32 v93, v93
v_exp_f32 v94, v94
v_mfma_f32_32x32x16_bf16 v[104:119], v[60:63], v[20:23], v[104:119]
v_exp_f32 v95, v95
v_exp_f32 v96, v96
v_exp_f32 v97, v97
v_smfmac_f32_16x16x64_bf16 v[160:163], v[168:171], v[88:95], v189
v_exp_f32 v98, v98
v_smfmac_f32_32x32x32_bf16 v[128:143], v[72:75], v[88:95], v189
v_exp_f32 v99, v99
v_exp_f32 v100, v100
v_exp_f32 v101, v101
v_exp_f32 v102, v102
v_exp_f32 v103, v103
s_waitcnt lgkmcnt(0)
v_exp_f32 v104, v104
v_exp_f32 v105, v105
v_smfmac_f32_16x16x64_bf16 v[160:163], v[168:171], v[96:103], v189
ds_read_b128 v[80:83], v2 offset:6144
ds_read_b128 v[84:87], v2 offset:7168
v_exp_f32 v106, v106
v_smfmac_f32_32x32x32_bf16 v[128:143], v[76:79], v[96:103], v189
s_cmp_eq_u32 s23, 0
s_cbranch_scc1 K2_w1a
s_waitcnt vmcnt(3)
K2_w1a:
s_cbranch_scc0 K2_w1b
s_waitcnt vmcnt(0)
K2_w1b:
v_cmp_ne_u32 vcc, 1, v178
s_nop 1
s_cbranch_vccnz K2_spinP1
K2_spinP1_b:
s_mov_b32 m0, s25
s_nop 0
buffer_load_dwordx4 v190, s[12:15], s24 offen offset:0 sc1 lds
buffer_load_dwordx4 v190, s[12:15], s24 offen offset:1024 sc1 lds
buffer_load_dwordx4 v190, s[12:15], s24 offen offset:2048 sc1 lds
buffer_load_dwordx4 v190, s[12:15], s24 offen offset:3072 sc1 lds
s_add_u32 s24, s24, 32768
s_and_b32 s24, s24, 0x3ffff
s_add_u32 s25, s25, 32768
s_sub_u32 s34, s25, 98304
s_min_u32 s25, s25, s34
buffer_load_dword v178, off, s[12:15], s64 sc1
v_exp_f32 v107, v107
v_exp_f32 v108, v108
v_mfma_f32_32x32x16_bf16 v[88:103], v[64:67], v[8:11], v[24:39]
v_exp_f32 v109, v109
v_exp_f32 v110, v110
v_mfma_f32_32x32x16_bf16 v[88:103], v[68:71], v[12:15], v[88:103]
v_exp_f32 v111, v111
v_exp_f32 v112, v112
v_exp_f32 v113, v113
v_smfmac_f32_16x16x64_bf16 v[164:167], v[168:171], v[104:111], v189
v_exp_f32 v114, v114
v_smfmac_f32_32x32x32_bf16 v[144:159], v[72:75], v[104:111], v189
v_exp_f32 v115, v115
v_exp_f32 v116, v116
v_exp_f32 v117, v117
v_exp_f32 v118, v118
v_exp_f32 v119, v119
s_waitcnt lgkmcnt(0)
v_exp_f32 v88, v88
v_exp_f32 v89, v89
v_smfmac_f32_16x16x64_bf16 v[164:167], v[168:171], v[112:119], v189
ds_read_b128 v[56:59], v2 offset:8192
ds_read_b128 v[60:63], v2 offset:9216
v_exp_f32 v90, v90
v_smfmac_f32_32x32x32_bf16 v[144:159], v[76:79], v[112:119], v189
v_exp_f32 v91, v91
v_exp_f32 v92, v92
v_mfma_f32_32x32x16_bf16 v[104:119], v[64:67], v[16:19], v[40:55]
v_exp_f32 v93, v93
v_exp_f32 v94, v94
v_mfma_f32_32x32x16_bf16 v[104:119], v[68:71], v[20:23], v[104:119]
v_exp_f32 v95, v95
v_exp_f32 v96, v96
v_exp_f32 v97, v97
v_smfmac_f32_16x16x64_bf16 v[160:163], v[168:171], v[88:95], v189
v_exp_f32 v98, v98
v_smfmac_f32_32x32x32_bf16 v[128:143], v[80:83], v[88:95], v189
v_exp_f32 v99, v99
v_exp_f32 v100, v100
v_exp_f32 v101, v101
v_exp_f32 v102, v102
v_exp_f32 v103, v103
s_waitcnt lgkmcnt(0)
v_exp_f32 v104, v104
v_exp_f32 v105, v105
v_smfmac_f32_16x16x64_bf16 v[160:163], v[168:171], v[96:103], v189
ds_read_b128 v[72:75], v2 offset:10240
ds_read_b128 v[76:79], v2 offset:11264
v_exp_f32 v106, v106
v_smfmac_f32_32x32x32_bf16 v[128:143], v[84:87], v[96:103], v189
v_exp_f32 v107, v107
v_exp_f32 v108, v108
v_mfma_f32_32x32x16_bf16 v[88:103], v[56:59], v[8:11], v[24:39]
v_exp_f32 v109, v109
v_exp_f32 v110, v110
v_mfma_f32_32x32x16_bf16 v[88:103], v[60:63], v[12:15], v[88:103]
v_exp_f32 v111, v111
v_exp_f32 v112, v112
v_exp_f32 v113, v113
v_smfmac_f32_16x16x64_bf16 v[164:167], v[168:171], v[104:111], v189
v_exp_f32 v114, v114
v_smfmac_f32_32x32x32_bf16 v[144:159], v[80:83], v[104:111], v189
v_exp_f32 v115, v115
v_exp_f32 v116, v116
v_exp_f32 v117, v117
v_exp_f32 v118, v118
v_exp_f32 v119, v119
s_waitcnt lgkmcnt(0)
v_exp_f32 v88, v88
v_exp_f32 v89, v89
v_smfmac_f32_16x16x64_bf16 v[164:167], v[168:171], v[112:119], v189
ds_read_b128 v[64:67], v2 offset:12288
ds_read_b128 v[68:71], v2 offset:13312
v_exp_f32 v90, v90
v_smfmac_f32_32x32x32_bf16 v[144:159], v[84:87], v[112:119], v189
v_exp_f32 v91, v91
v_exp_f32 v92, v92
v_mfma_f32_32x32x16_bf16 v[104:119], v[56:59], v[16:19], v[40:55]
v_exp_f32 v93, v93
v_exp_f32 v94, v94
v_mfma_f32_32x32x16_bf16 v[104:119], v[60:63], v[20:23], v[104:119]
v_exp_f32 v95, v95
v_exp_f32 v96, v96
v_exp_f32 v97, v97
v_smfmac_f32_16x16x64_bf16 v[160:163], v[168:171], v[88:95], v189
v_exp_f32 v98, v98
v_smfmac_f32_32x32x32_bf16 v[128:143], v[72:75], v[88:95], v189
v_exp_f32 v99, v99
v_exp_f32 v100, v100
v_exp_f32 v101, v101
v_exp_f32 v102, v102
v_exp_f32 v103, v103
s_waitcnt lgkmcnt(0)
v_exp_f32 v104, v104
v_exp_f32 v105, v105
v_smfmac_f32_16x16x64_bf16 v[160:163], v[168:171], v[96:103], v189
ds_read_b128 v[80:83], v2 offset:14336
ds_read_b128 v[84:87], v2 offset:15360
v_exp_f32 v106, v106
v_smfmac_f32_32x32x32_bf16 v[128:143], v[76:79], v[96:103], v189
v_exp_f32 v107, v107
v_exp_f32 v108, v108
v_mfma_f32_32x32x16_bf16 v[88:103], v[64:67], v[8:11], v[24:39]
v_exp_f32 v109, v109
v_exp_f32 v110, v110
v_mfma_f32_32x32x16_bf16 v[88:103], v[68:71], v[12:15], v[88:103]
v_exp_f32 v111, v111
v_exp_f32 v112, v112
v_exp_f32 v113, v113
v_smfmac_f32_16x16x64_bf16 v[164:167], v[168:171], v[104:111], v189
v_exp_f32 v114, v114
v_smfmac_f32_32x32x32_bf16 v[144:159], v[72:75], v[104:111], v189
v_exp_f32 v115, v115
v_exp_f32 v116, v116
v_exp_f32 v117, v117
v_exp_f32 v118, v118
v_exp_f32 v119, v119
s_waitcnt lgkmcnt(0)
s_waitcnt vmcnt(0)
v_cmp_ne_u32 vcc, 1, v178
s_barrier
s_cbranch_vccnz K2_spinP2
K2_spinP2_b:
s_cmp_eq_u32 s23, 0
s_cbranch_scc1 K2_nofA
s_add_u32 s34, s95, 16
v_mov_b32 v4, 1
s_mov_b64 exec, 1
buffer_store_dword v4, off, s[12:15], s34 sc1
s_mov_b64 exec, -1
K2_nofA:
v_exp_f32 v88, v88
v_exp_f32 v89, v89
v_smfmac_f32_16x16x64_bf16 v[164:167], v[168:171], v[112:119], v189
ds_read_b128 v[56:59], v3 offset:0
ds_read_b128 v[60:63], v3 offset:1024
v_exp_f32 v90, v90
v_smfmac_f32_32x32x32_bf16 v[144:159], v[76:79], v[112:119], v189
s_mov_b32 m0, s25
s_nop 0
buffer_load_dwordx4 v190, s[12:15], s24 offen offset:0 sc1 lds
buffer_load_dwordx4 v190, s[12:15], s24 offen offset:1024 sc1 lds
buffer_load_dwordx4 v190, s[12:15], s24 offen offset:2048 sc1 lds
buffer_load_dwordx4 v190, s[12:15], s24 offen offset:3072 sc1 lds
s_add_u32 s24, s24, 32768
s_and_b32 s24, s24, 0x3ffff
s_add_u32 s25, s25, 32768
s_sub_u32 s34, s25, 98304
s_min_u32 s25, s25, s34
s_cmp_lt_u32 s20, 4
s_cselect_b32 s52, s42, s44
s_cselect_b32 s53, s43, s45
s_mov_b32 s54, 2097152
s_mov_b32 s55, 0x20000
s_and_b32 s34, s20, 3
s_lshl_b32 s35, s2, 2
s_add_u32 s34, s34, s35
s_lshl_b32 s34, s34, 11
v_lshlrev_b32 v4, 5, v0
buffer_load_dword v243, v4, s[52:55], s34 offen
v_exp_f32 v91, v91
v_exp_f32 v92, v92
v_mfma_f32_32x32x16_bf16 v[104:119], v[64:67], v[16:19], v[40:55]
v_exp_f32 v93, v93
v_exp_f32 v94, v94
v_mfma_f32_32x32x16_bf16 v[104:119], v[68:71], v[20:23], v[104:119]
v_exp_f32 v95, v95
v_exp_f32 v96, v96
v_exp_f32 v97, v97
v_smfmac_f32_16x16x64_bf16 v[160:163], v[168:171], v[88:95], v189
v_exp_f32 v98, v98
v_smfmac_f32_32x32x32_bf16 v[128:143], v[80:83], v[88:95], v189
v_exp_f32 v99, v99
v_exp_f32 v100, v100
v_exp_f32 v101, v101
v_exp_f32 v102, v102
v_exp_f32 v103, v103
s_waitcnt lgkmcnt(0)
v_exp_f32 v104, v104
v_exp_f32 v105, v105
v_smfmac_f32_16x16x64_bf16 v[160:163], v[168:171], v[96:103], v189
ds_read_b128 v[72:75], v3 offset:2048
ds_read_b128 v[76:79], v3 offset:3072
v_exp_f32 v106, v106
v_smfmac_f32_32x32x32_bf16 v[128:143], v[84:87], v[96:103], v189
v_exp_f32 v107, v107
v_exp_f32 v108, v108
v_mfma_f32_32x32x16_bf16 v[88:103], v[56:59], v[8:11], v[24:39]
v_exp_f32 v109, v109
v_exp_f32 v110, v110
v_mfma_f32_32x32x16_bf16 v[88:103], v[60:63], v[12:15], v[88:103]
v_exp_f32 v111, v111
v_exp_f32 v112, v112
v_exp_f32 v113, v113
v_smfmac_f32_16x16x64_bf16 v[164:167], v[168:171], v[104:111], v189
v_exp_f32 v114, v114
v_smfmac_f32_32x32x32_bf16 v[144:159], v[80:83], v[104:111], v189
v_exp_f32 v115, v115
v_exp_f32 v116, v116
v_exp_f32 v117, v117
v_exp_f32 v118, v118
v_exp_f32 v119, v119
v_mov_b32 v2, v3
s_add_u32 s26, s26, 32768
s_sub_u32 s34, s26, 98304
s_min_u32 s26, s26, s34
v_add_u32 v3, s26, v1
s_waitcnt lgkmcnt(0)
v_exp_f32 v88, v88
v_exp_f32 v89, v89
v_smfmac_f32_16x16x64_bf16 v[164:167], v[168:171], v[112:119], v189
ds_read_b128 v[64:67], v2 offset:4096
ds_read_b128 v[68:71], v2 offset:5120
v_exp_f32 v90, v90
v_smfmac_f32_32x32x32_bf16 v[144:159], v[84:87], v[112:119], v189
v_exp_f32 v91, v91
v_exp_f32 v92, v92
v_mfma_f32_32x32x16_bf16 v[104:119], v[56:59], v[16:19], v[40:55]
v_exp_f32 v93, v93
v_exp_f32 v94, v94
v_mfma_f32_32x32x16_bf16 v[104:119], v[60:63], v[20:23], v[104:119]
v_exp_f32 v95, v95
v_exp_f32 v96, v96
v_exp_f32 v97, v97
v_smfmac_f32_16x16x64_bf16 v[160:163], v[168:171], v[88:95], v189
v_exp_f32 v98, v98
v_smfmac_f32_32x32x32_bf16 v[128:143], v[72:75], v[88:95], v189
v_exp_f32 v99, v99
v_exp_f32 v100, v100
v_exp_f32 v101, v101
v_exp_f32 v102, v102
v_exp_f32 v103, v103
s_waitcnt lgkmcnt(0)
v_exp_f32 v104, v104
v_exp_f32 v105, v105
v_smfmac_f32_16x16x64_bf16 v[160:163], v[168:171], v[96:103], v189
ds_read_b128 v[80:83], v2 offset:6144
ds_read_b128 v[84:87], v2 offset:7168
v_exp_f32 v106, v106
v_smfmac_f32_32x32x32_bf16 v[128:143], v[76:79], v[96:103], v189
v_exp_f32 v107, v107
v_exp_f32 v108, v108
v_mfma_f32_32x32x16_bf16 v[88:103], v[64:67], v[8:11], v[24:39]
v_exp_f32 v109, v109
v_exp_f32 v110, v110
v_mfma_f32_32x32x16_bf16 v[88:103], v[68:71], v[12:15], v[88:103]
v_exp_f32 v111, v111
v_exp_f32 v112, v112
v_exp_f32 v113, v113
v_smfmac_f32_16x16x64_bf16 v[164:167], v[168:171], v[104:111], v189
v_exp_f32 v114, v114
v_smfmac_f32_32x32x32_bf16 v[144:159], v[72:75], v[104:111], v189
v_exp_f32 v115, v115
v_exp_f32 v116, v116
v_exp_f32 v117, v117
v_exp_f32 v118, v118
v_exp_f32 v119, v119
s_waitcnt lgkmcnt(0)
v_exp_f32 v88, v88
v_exp_f32 v89, v89
v_smfmac_f32_16x16x64_bf16 v[164:167], v[168:171], v[112:119], v189
ds_read_b128 v[56:59], v2 offset:8192
ds_read_b128 v[60:63], v2 offset:9216
v_exp_f32 v90, v90
v_smfmac_f32_32x32x32_bf16 v[144:159], v[76:79], v[112:119], v189
buffer_load_dword v178, v188, s[12:15], 0 offen sc1
v_exp_f32 v91, v91
v_exp_f32 v92, v92
v_mfma_f32_32x32x16_bf16 v[104:119], v[64:67], v[16:19], v[40:55]
v_exp_f32 v93, v93
v_exp_f32 v94, v94
v_mfma_f32_32x32x16_bf16 v[104:119], v[68:71], v[20:23], v[104:119]
v_exp_f32 v95, v95
v_exp_f32 v96, v96
v_exp_f32 v97, v97
v_smfmac_f32_16x16x64_bf16 v[160:163], v[168:171], v[88:95], v189
v_exp_f32 v98, v98
v_smfmac_f32_32x32x32_bf16 v[128:143], v[80:83], v[88:95], v189
v_exp_f32 v99, v99
v_exp_f32 v100, v100
v_exp_f32 v101, v101
v_exp_f32 v102, v102
v_exp_f32 v103, v103
s_waitcnt lgkmcnt(0)
v_exp_f32 v104, v104
v_exp_f32 v105, v105
v_smfmac_f32_16x16x64_bf16 v[160:163], v[168:171], v[96:103], v189
ds_read_b128 v[72:75], v2 offset:10240
ds_read_b128 v[76:79], v2 offset:11264
v_exp_f32 v106, v106
v_smfmac_f32_32x32x32_bf16 v[128:143], v[84:87], v[96:103], v189
v_exp_f32 v107, v107
v_exp_f32 v108, v108
v_mfma_f32_32x32x16_bf16 v[88:103], v[56:59], v[8:11], v[24:39]
v_exp_f32 v109, v109
v_exp_f32 v110, v110
v_mfma_f32_32x32x16_bf16 v[88:103], v[60:63], v[12:15], v[88:103]
v_exp_f32 v111, v111
v_exp_f32 v112, v112
v_exp_f32 v113, v113
v_smfmac_f32_16x16x64_bf16 v[164:167], v[168:171], v[104:111], v189
v_exp_f32 v114, v114
v_smfmac_f32_32x32x32_bf16 v[144:159], v[80:83], v[104:111], v189
v_exp_f32 v115, v115
v_exp_f32 v116, v116
v_exp_f32 v117, v117
v_exp_f32 v118, v118
v_exp_f32 v119, v119
s_waitcnt lgkmcnt(0)
v_exp_f32 v88, v88
v_exp_f32 v89, v89
v_smfmac_f32_16x16x64_bf16 v[164:167], v[168:171], v[112:119], v189
ds_read_b128 v[64:67], v2 offset:12288
ds_read_b128 v[68:71], v2 offset:13312
v_exp_f32 v90, v90
v_smfmac_f32_32x32x32_bf16 v[144:159], v[84:87], v[112:119], v189
v_exp_f32 v91, v91
v_exp_f32 v92, v92
v_mfma_f32_32x32x16_bf16 v[104:119], v[56:59], v[16:19], v[40:55]
v_exp_f32 v93, v93
v_exp_f32 v94, v94
v_mfma_f32_32x32x16_bf16 v[104:119], v[60:63], v[20:23], v[104:119]
v_exp_f32 v95, v95
v_exp_f32 v96, v96
v_exp_f32 v97, v97
v_smfmac_f32_16x16x64_bf16 v[160:163], v[168:171], v[88:95], v189
v_exp_f32 v98, v98
v_smfmac_f32_32x32x32_bf16 v[128:143], v[72:75], v[88:95], v189
v_exp_f32 v99, v99
v_exp_f32 v100, v100
v_exp_f32 v101, v101
v_exp_f32 v102, v102
v_exp_f32 v103, v103
s_waitcnt lgkmcnt(0)
v_exp_f32 v104, v104
v_exp_f32 v105, v105
v_smfmac_f32_16x16x64_bf16 v[160:163], v[168:171], v[96:103], v189
ds_read_b128 v[80:83], v2 offset:14336
ds_read_b128 v[84:87], v2 offset:15360
v_exp_f32 v106, v106
v_smfmac_f32_32x32x32_bf16 v[128:143], v[76:79], v[96:103], v189
v_exp_f32 v107, v107
v_exp_f32 v108, v108
v_mfma_f32_32x32x16_bf16 v[88:103], v[64:67], v[8:11], v[24:39]
v_exp_f32 v109, v109
v_exp_f32 v110, v110
v_mfma_f32_32x32x16_bf16 v[88:103], v[68:71], v[12:15], v[88:103]
v_exp_f32 v111, v111
v_exp_f32 v112, v112
v_exp_f32 v113, v113
v_smfmac_f32_16x16x64_bf16 v[164:167], v[168:171], v[104:111], v189
v_exp_f32 v114, v114
v_smfmac_f32_32x32x32_bf16 v[144:159], v[72:75], v[104:111], v189
v_exp_f32 v115, v115
v_exp_f32 v116, v116
v_exp_f32 v117, v117
v_exp_f32 v118, v118
v_exp_f32 v119, v119
s_waitcnt lgkmcnt(0)
s_waitcnt vmcnt(0)
v_cmp_ne_u32 vcc, 1, v178
s_barrier
s_cbranch_vccnz K2_spinA1
K2_spinA1_b:
v_exp_f32 v88, v88
v_exp_f32 v89, v89
v_smfmac_f32_16x16x64_bf16 v[164:167], v[168:171], v[112:119], v189
ds_read_b128 v[56:59], v3 offset:0
ds_read_b128 v[60:63], v3 offset:1024
v_exp_f32 v90, v90
v_smfmac_f32_32x32x32_bf16 v[144:159], v[76:79], v[112:119], v189
s_mov_b32 m0, s25
s_nop 0
buffer_load_dwordx4 v190, s[12:15], s24 offen offset:0 sc1 lds
buffer_load_dwordx4 v190, s[12:15], s24 offen offset:1024 sc1 lds
buffer_load_dwordx4 v190, s[12:15], s24 offen offset:2048 sc1 lds
buffer_load_dwordx4 v190, s[12:15], s24 offen offset:3072 sc1 lds
s_add_u32 s24, s24, 32768
s_and_b32 s24, s24, 0x3ffff
s_add_u32 s25, s25, 32768
s_sub_u32 s34, s25, 98304
s_min_u32 s25, s25, s34
v_exp_f32 v91, v91
v_exp_f32 v92, v92
v_mfma_f32_32x32x16_bf16 v[104:119], v[64:67], v[16:19], v[40:55]
v_exp_f32 v93, v93
v_exp_f32 v94, v94
v_mfma_f32_32x32x16_bf16 v[104:119], v[68:71], v[20:23], v[104:119]
v_exp_f32 v95, v95
v_exp_f32 v96, v96
v_exp_f32 v97, v97
v_smfmac_f32_16x16x64_bf16 v[160:163], v[168:171], v[88:95], v189
v_exp_f32 v98, v98
v_smfmac_f32_32x32x32_bf16 v[128:143], v[80:83], v[88:95], v189
v_exp_f32 v99, v99
v_exp_f32 v100, v100
v_exp_f32 v101, v101
v_exp_f32 v102, v102
v_exp_f32 v103, v103
s_waitcnt lgkmcnt(0)
v_exp_f32 v104, v104
v_exp_f32 v105, v105
v_smfmac_f32_16x16x64_bf16 v[160:163], v[168:171], v[96:103], v189
ds_read_b128 v[72:75], v3 offset:2048
ds_read_b128 v[76:79], v3 offset:3072
v_exp_f32 v106, v106
v_smfmac_f32_32x32x32_bf16 v[128:143], v[84:87], v[96:103], v189
v_exp_f32 v107, v107
v_exp_f32 v108, v108
v_mfma_f32_32x32x16_bf16 v[88:103], v[56:59], v[8:11], v[24:39]
v_exp_f32 v109, v109
v_exp_f32 v110, v110
v_mfma_f32_32x32x16_bf16 v[88:103], v[60:63], v[12:15], v[88:103]
v_exp_f32 v111, v111
v_exp_f32 v112, v112
v_exp_f32 v113, v113
v_smfmac_f32_16x16x64_bf16 v[164:167], v[168:171], v[104:111], v189
v_exp_f32 v114, v114
v_smfmac_f32_32x32x32_bf16 v[144:159], v[80:83], v[104:111], v189
v_exp_f32 v115, v115
v_exp_f32 v116, v116
v_exp_f32 v117, v117
v_exp_f32 v118, v118
v_exp_f32 v119, v119
v_mov_b32 v2, v3
s_add_u32 s26, s26, 32768
s_sub_u32 s34, s26, 98304
s_min_u32 s26, s26, s34
v_add_u32 v3, s26, v1
s_waitcnt lgkmcnt(0)
v_exp_f32 v88, v88
v_exp_f32 v89, v89
v_smfmac_f32_16x16x64_bf16 v[164:167], v[168:171], v[112:119], v189
ds_read_b128 v[64:67], v2 offset:4096
ds_read_b128 v[68:71], v2 offset:5120
v_exp_f32 v90, v90
v_smfmac_f32_32x32x32_bf16 v[144:159], v[84:87], v[112:119], v189
buffer_load_dwordx4 v[192:195], v1, s[12:15], s58 offen sc1
s_add_u32 s58, s58, 8192
buffer_load_dwordx4 v[196:199], v1, s[12:15], s58 offen sc1
s_add_u32 s58, s58, 8192
v_exp_f32 v91, v91
v_exp_f32 v92, v92
v_mfma_f32_32x32x16_bf16 v[104:119], v[56:59], v[16:19], v[40:55]
v_exp_f32 v93, v93
v_exp_f32 v94, v94
v_mfma_f32_32x32x16_bf16 v[104:119], v[60:63], v[20:23], v[104:119]
v_exp_f32 v95, v95
v_exp_f32 v96, v96
v_exp_f32 v97, v97
v_smfmac_f32_16x16x64_bf16 v[160:163], v[168:171], v[88:95], v189
v_exp_f32 v98, v98
v_smfmac_f32_32x32x32_bf16 v[128:143], v[72:75], v[88:95], v189
v_exp_f32 v99, v99
v_exp_f32 v100, v100
v_exp_f32 v101, v101
v_exp_f32 v102, v102
v_exp_f32 v103, v103
s_waitcnt lgkmcnt(0)
v_exp_f32 v104, v104
v_exp_f32 v105, v105
v_smfmac_f32_16x16x64_bf16 v[160:163], v[168:171], v[96:103], v189
ds_read_b128 v[80:83], v2 offset:6144
ds_read_b128 v[84:87], v2 offset:7168
v_exp_f32 v106, v106
v_smfmac_f32_32x32x32_bf16 v[128:143], v[76:79], v[96:103], v189
buffer_load_dwordx4 v[200:203], v1, s[12:15], s58 offen sc1
s_add_u32 s58, s58, 8192
buffer_load_dwordx4 v[204:207], v1, s[12:15], s58 offen sc1
s_add_u32 s58, s58, 8192
v_exp_f32 v107, v107
v_exp_f32 v108, v108
v_mfma_f32_32x32x16_bf16 v[88:103], v[64:67], v[8:11], v[24:39]
v_exp_f32 v109, v109
v_exp_f32 v110, v110
v_mfma_f32_32x32x16_bf16 v[88:103], v[68:71], v[12:15], v[88:103]
v_exp_f32 v111, v111
v_exp_f32 v112, v112
v_exp_f32 v113, v113
v_smfmac_f32_16x16x64_bf16 v[164:167], v[168:171], v[104:111], v189
v_exp_f32 v114, v114
v_smfmac_f32_32x32x32_bf16 v[144:159], v[72:75], v[104:111], v189
v_exp_f32 v115, v115
v_exp_f32 v116, v116
v_exp_f32 v117, v117
v_exp_f32 v118, v118
v_exp_f32 v119, v119
s_waitcnt lgkmcnt(0)
v_exp_f32 v88, v88
v_exp_f32 v89, v89
v_smfmac_f32_16x16x64_bf16 v[164:167], v[168:171], v[112:119], v189
ds_read_b128 v[56:59], v2 offset:8192
ds_read_b128 v[60:63], v2 offset:9216
v_exp_f32 v90, v90
v_smfmac_f32_32x32x32_bf16 v[144:159], v[76:79], v[112:119], v189
buffer_load_dwordx4 v[208:211], v1, s[12:15], s58 offen sc1
s_add_u32 s58, s58, 8192
buffer_load_dwordx4 v[212:215], v1, s[12:15], s58 offen sc1
s_add_u32 s58, s58, 8192
v_exp_f32 v91, v91
v_exp_f32 v92, v92
v_mfma_f32_32x32x16_bf16 v[104:119], v[64:67], v[16:19], v[40:55]
v_exp_f32 v93, v93
v_exp_f32 v94, v94
v_mfma_f32_32x32x16_bf16 v[104:119], v[68:71], v[20:23], v[104:119]
v_exp_f32 v95, v95
v_exp_f32 v96, v96
v_exp_f32 v97, v97
v_smfmac_f32_16x16x64_bf16 v[160:163], v[168:171], v[88:95], v189
v_exp_f32 v98, v98
v_smfmac_f32_32x32x32_bf16 v[128:143], v[80:83], v[88:95], v189
v_exp_f32 v99, v99
v_exp_f32 v100, v100
v_exp_f32 v101, v101
v_exp_f32 v102, v102
v_exp_f32 v103, v103
s_waitcnt lgkmcnt(0)
v_exp_f32 v104, v104
v_exp_f32 v105, v105
v_smfmac_f32_16x16x64_bf16 v[160:163], v[168:171], v[96:103], v189
ds_read_b128 v[72:75], v2 offset:10240
ds_read_b128 v[76:79], v2 offset:11264
v_exp_f32 v106, v106
v_smfmac_f32_32x32x32_bf16 v[128:143], v[84:87], v[96:103], v189
buffer_load_dwordx4 v[216:219], v1, s[12:15], s58 offen sc1
s_add_u32 s58, s58, 8192
buffer_load_dwordx4 v[220:223], v1, s[12:15], s58 offen sc1
s_add_u32 s58, s58, 8192
v_exp_f32 v107, v107
v_exp_f32 v108, v108
v_mfma_f32_32x32x16_bf16 v[88:103], v[56:59], v[8:11], v[24:39]
v_exp_f32 v109, v109
v_exp_f32 v110, v110
v_mfma_f32_32x32x16_bf16 v[88:103], v[60:63], v[12:15], v[88:103]
v_exp_f32 v111, v111
v_exp_f32 v112, v112
v_exp_f32 v113, v113
v_smfmac_f32_16x16x64_bf16 v[164:167], v[168:171], v[104:111], v189
v_exp_f32 v114, v114
v_smfmac_f32_32x32x32_bf16 v[144:159], v[80:83], v[104:111], v189
v_exp_f32 v115, v115
v_exp_f32 v116, v116
v_exp_f32 v117, v117
v_exp_f32 v118, v118
v_exp_f32 v119, v119
s_waitcnt lgkmcnt(0)
v_exp_f32 v88, v88
v_exp_f32 v89, v89
v_smfmac_f32_16x16x64_bf16 v[164:167], v[168:171], v[112:119], v189
ds_read_b128 v[64:67], v2 offset:12288
ds_read_b128 v[68:71], v2 offset:13312
v_exp_f32 v90, v90
v_smfmac_f32_32x32x32_bf16 v[144:159], v[84:87], v[112:119], v189
v_lshrrev_b32 v4, 3, v0
v_lshlrev_b32 v4, 8, v4
v_and_b32 v5, 7, v0
v_lshl_add_u32 v4, v5, 2, v4
buffer_load_dword v176, v4, s[12:15], s48 offen sc1
v_bfe_u32 v5, v0, 3, 2
v_lshlrev_b32 v5, 7, v5
v_and_b32 v6, 7, v0
v_lshl_add_u32 v5, v6, 2, v5
buffer_load_dword v177, v5, s[12:15], s57 offen sc1
v_exp_f32 v91, v91
v_exp_f32 v92, v92
v_mfma_f32_32x32x16_bf16 v[104:119], v[56:59], v[16:19], v[40:55]
v_exp_f32 v93, v93
v_exp_f32 v94, v94
v_mfma_f32_32x32x16_bf16 v[104:119], v[60:63], v[20:23], v[104:119]
v_exp_f32 v95, v95
v_exp_f32 v96, v96
v_exp_f32 v97, v97
v_smfmac_f32_16x16x64_bf16 v[160:163], v[168:171], v[88:95], v189
v_exp_f32 v98, v98
v_smfmac_f32_32x32x32_bf16 v[128:143], v[72:75], v[88:95], v189
v_exp_f32 v99, v99
v_exp_f32 v100, v100
v_exp_f32 v101, v101
v_exp_f32 v102, v102
v_exp_f32 v103, v103
s_waitcnt lgkmcnt(0)
v_exp_f32 v104, v104
v_exp_f32 v105, v105
v_smfmac_f32_16x16x64_bf16 v[160:163], v[168:171], v[96:103], v189
ds_read_b128 v[80:83], v2 offset:14336
ds_read_b128 v[84:87], v2 offset:15360
v_exp_f32 v106, v106
v_smfmac_f32_32x32x32_bf16 v[128:143], v[76:79], v[96:103], v189
v_add_u32 v4, s49, v1
ds_read_b128 v[180:183], v4
ds_read_b128 v[184:187], v4 offset:1024
v_exp_f32 v107, v107
v_exp_f32 v108, v108
v_mfma_f32_32x32x16_bf16 v[88:103], v[64:67], v[8:11], v[24:39]
v_exp_f32 v109, v109
v_exp_f32 v110, v110
v_mfma_f32_32x32x16_bf16 v[88:103], v[68:71], v[12:15], v[88:103]
v_exp_f32 v111, v111
v_exp_f32 v112, v112
v_exp_f32 v113, v113
v_smfmac_f32_16x16x64_bf16 v[164:167], v[168:171], v[104:111], v189
v_exp_f32 v114, v114
v_smfmac_f32_32x32x32_bf16 v[144:159], v[72:75], v[104:111], v189
v_exp_f32 v115, v115
v_exp_f32 v116, v116
v_exp_f32 v117, v117
v_exp_f32 v118, v118
v_exp_f32 v119, v119
s_waitcnt lgkmcnt(0)
s_waitcnt vmcnt(0)
s_barrier
v_exp_f32 v88, v88
v_exp_f32 v89, v89
v_smfmac_f32_16x16x64_bf16 v[164:167], v[168:171], v[112:119], v189
ds_read_b128 v[56:59], v3 offset:0
ds_read_b128 v[60:63], v3 offset:1024
v_exp_f32 v90, v90
v_smfmac_f32_32x32x32_bf16 v[144:159], v[76:79], v[112:119], v189
s_mov_b32 m0, s25
s_nop 0
buffer_load_dwordx4 v190, s[12:15], s24 offen offset:0 sc1 lds
buffer_load_dwordx4 v190, s[12:15], s24 offen offset:1024 sc1 lds
buffer_load_dwordx4 v190, s[12:15], s24 offen offset:2048 sc1 lds
buffer_load_dwordx4 v190, s[12:15], s24 offen offset:3072 sc1 lds
s_add_u32 s24, s24, 32768
s_and_b32 s24, s24, 0x3ffff
s_add_u32 s25, s25, 32768
s_sub_u32 s34, s25, 98304
s_min_u32 s25, s25, s34
v_exp_f32 v91, v91
v_exp_f32 v92, v92
v_mfma_f32_32x32x16_bf16 v[104:119], v[64:67], v[16:19], v[40:55]
v_exp_f32 v93, v93
v_exp_f32 v94, v94
v_mfma_f32_32x32x16_bf16 v[104:119], v[68:71], v[20:23], v[104:119]
v_exp_f32 v95, v95
v_exp_f32 v96, v96
v_exp_f32 v97, v97
v_smfmac_f32_16x16x64_bf16 v[160:163], v[168:171], v[88:95], v189
v_exp_f32 v98, v98
v_smfmac_f32_32x32x32_bf16 v[128:143], v[80:83], v[88:95], v189
v_exp_f32 v99, v99
v_exp_f32 v100, v100
v_exp_f32 v101, v101
v_exp_f32 v102, v102
v_exp_f32 v103, v103
s_waitcnt lgkmcnt(0)
v_exp_f32 v104, v104
v_exp_f32 v105, v105
v_smfmac_f32_16x16x64_bf16 v[160:163], v[168:171], v[96:103], v189
ds_read_b128 v[72:75], v3 offset:2048
ds_read_b128 v[76:79], v3 offset:3072
v_exp_f32 v106, v106
v_smfmac_f32_32x32x32_bf16 v[128:143], v[84:87], v[96:103], v189
v_exp_f32 v107, v107
v_exp_f32 v108, v108
v_mfma_f32_32x32x16_bf16 v[88:103], v[56:59], v[8:11], v[24:39]
v_exp_f32 v109, v109
v_exp_f32 v110, v110
v_mfma_f32_32x32x16_bf16 v[88:103], v[60:63], v[12:15], v[88:103]
v_exp_f32 v111, v111
v_exp_f32 v112, v112
v_exp_f32 v113, v113
v_smfmac_f32_16x16x64_bf16 v[164:167], v[168:171], v[104:111], v189
v_exp_f32 v114, v114
v_smfmac_f32_32x32x32_bf16 v[144:159], v[80:83], v[104:111], v189
v_exp_f32 v115, v115
v_exp_f32 v116, v116
v_exp_f32 v117, v117
v_exp_f32 v118, v118
v_exp_f32 v119, v119
v_mov_b32 v2, v3
s_add_u32 s26, s26, 32768
s_sub_u32 s34, s26, 98304
s_min_u32 s26, s26, s34
v_add_u32 v3, s26, v1
v_mov_b32 v240, 0
v_mov_b32 v241, 0
v_mov_b32 v242, 0
v_mov_b32 v243, 0
v_mov_b32 v178, 104576
ds_write_b128 v178, v[240:243]
v_lshrrev_b32 v6, 5, v0
v_bfe_u32 v7, v0, 2, 2
v_lshl_add_u32 v6, v6, 2, v7
v_lshlrev_b32 v6, 6, v6
v_bfe_u32 v7, v0, 4, 1
v_lshl_add_u32 v6, v7, 5, v6
v_and_b32 v7, 3, v0
v_lshl_add_u32 v6, v7, 3, v6
v_add_u32 v6, 159744, v6
ds_read_b64_tr_b16 v[64:65], v6 offset:0
ds_read_b64_tr_b16 v[66:67], v6 offset:1024
ds_read_b64_tr_b16 v[68:69], v6 offset:512
ds_read_b64_tr_b16 v[70:71], v6 offset:1536
v_pk_add_f32 v[192:193], v[192:193], v[196:197]
v_pk_add_f32 v[194:195], v[194:195], v[198:199]
v_pk_add_f32 v[200:201], v[200:201], v[204:205]
v_pk_add_f32 v[202:203], v[202:203], v[206:207]
v_pk_add_f32 v[208:209], v[208:209], v[212:213]
v_pk_add_f32 v[210:211], v[210:211], v[214:215]
v_pk_add_f32 v[216:217], v[216:217], v[220:221]
v_pk_add_f32 v[218:219], v[218:219], v[222:223]
v_pk_add_f32 v[192:193], v[192:193], v[200:201]
v_pk_add_f32 v[194:195], v[194:195], v[202:203]
v_pk_add_f32 v[208:209], v[208:209], v[216:217]
v_pk_add_f32 v[210:211], v[210:211], v[218:219]
v_pk_add_f32 v[192:193], v[192:193], v[208:209]
v_pk_add_f32 v[194:195], v[194:195], v[210:211]
v_cvt_pk_bf16_f32 v4, v192, v193
v_cvt_pk_bf16_f32 v5, v194, v195
s_lshr_b32 s34, s20, 1
s_lshl_b32 s34, s34, 10
s_and_b32 s35, s20, 1
s_lshl_b32 s35, s35, 3
s_add_u32 s34, s34, s35
s_add_u32 s34, s34, 98304
v_add_u32 v6, s34, v1
ds_write_b64 v6, v[4:5]
v_add_f32_dpp v176, v176, v176 row_ror:8 row_mask:0xf bank_mask:0xf
s_nop 0
v_mov_b32 v7, v176
s_nop 1
v_permlane16_swap_b32 v176, v7
v_add_f32 v176, v176, v7
v_mov_b32 v7, v176
s_nop 1
v_permlane32_swap_b32 v176, v7
v_add_f32 v176, v176, v7
v_cvt_pk_bf16_f32 v176, v176, v176
s_lshr_b32 s34, s20, 1
s_lshl_b32 s34, s34, 5
s_and_b32 s35, s20, 1
s_lshl_b32 s35, s35, 3
s_add_u32 s34, s34, s35
s_add_u32 s34, s34, 104448
v_bfe_u32 v7, v0, 2, 1
v_lshlrev_b32 v7, 4, v7
v_and_b32 v6, 3, v0
v_lshl_add_u32 v7, v6, 1, v7
v_add_u32 v7, s34, v7
ds_write_b16 v7, v176
s_waitcnt lgkmcnt(0)
v_mfma_f32_32x32x16_bf16 v[192:207], v[64:67], v[180:183], 0
v_mfma_f32_32x32x16_bf16 v[192:207], v[68:71], v[184:187], v[192:207]
s_barrier
v_add_u32 v7, 98304, v1
ds_read_b128 v[224:227], v7 offset:0
ds_read_b128 v[228:231], v7 offset:1024
ds_read_b128 v[232:235], v7 offset:2048
ds_read_b128 v[236:239], v7 offset:3072
v_lshrrev_b32 v6, 5, v0
v_lshlrev_b32 v6, 4, v6
v_add_u32 v6, 104448, v6
v_lshrrev_b32 v4, 4, v0
v_lshrrev_b32 v5, 2, v0
v_xor_b32 v4, v4, v5
v_and_b32 v4, 1, v4
v_cmp_eq_u32 vcc, 1, v4
s_mov_b32 s60, 0x3fb8aa3b
s_mov_b32 s61, 0xbfb8aa3b
v_add_u32 v7, 0, v6
v_mov_b32 v240, 104576
v_cndmask_b32 v7, v7, v240, vcc
ds_read_b128 v[240:243], v7
v_add_u32 v7, 32, v6
v_mov_b32 v244, 104576
v_cndmask_b32 v7, v7, v244, vcc
ds_read_b128 v[244:247], v7
v_add_u32 v7, 64, v6
v_mov_b32 v248, 104576
v_cndmask_b32 v7, v7, v248, vcc
ds_read_b128 v[248:251], v7
v_add_u32 v7, 96, v6
v_mov_b32 v252, 104576
v_cndmask_b32 v7, v7, v252, vcc
ds_read_b128 v[252:255], v7
v_max3_f32 v4, v192, v193, v194
v_min3_f32 v5, v192, v193, v194
v_max3_f32 v4, v4, v195, v196
v_min3_f32 v5, v5, v195, v196
v_max3_f32 v4, v4, v197, v198
v_min3_f32 v5, v5, v197, v198
v_max3_f32 v4, v4, v199, v200
v_min3_f32 v5, v5, v199, v200
v_max3_f32 v4, v4, v201, v202
v_min3_f32 v5, v5, v201, v202
v_max3_f32 v4, v4, v203, v204
v_min3_f32 v5, v5, v203, v204
v_max3_f32 v4, v4, v205, v206
v_min3_f32 v5, v5, v205, v206
v_max_f32 v4, v4, v207
v_min_f32 v5, v5, v207
v_mov_b32 v6, v4
v_mov_b32 v7, v5
s_nop 0
v_permlane32_swap_b32 v4, v6
v_permlane32_swap_b32 v5, v7
v_max_f32 v4, v4, v6
v_min_f32 v5, v5, v7
v_mul_f32 v4, s61, v4
v_mul_f32 v5, s60, v5
v_fma_f32 v208, v192, s61, v5
v_fma_f32 v209, v193, s61, v5
v_fma_f32 v210, v194, s61, v5
v_fma_f32 v211, v195, s61, v5
v_fma_f32 v212, v196, s61, v5
v_fma_f32 v213, v197, s61, v5
v_fma_f32 v214, v198, s61, v5
v_fma_f32 v215, v199, s61, v5
v_fma_f32 v216, v200, s61, v5
v_fma_f32 v217, v201, s61, v5
v_fma_f32 v218, v202, s61, v5
v_fma_f32 v219, v203, s61, v5
v_fma_f32 v220, v204, s61, v5
v_fma_f32 v221, v205, s61, v5
v_fma_f32 v222, v206, s61, v5
v_fma_f32 v223, v207, s61, v5
v_fma_f32 v192, v192, s60, v4
v_fma_f32 v193, v193, s60, v4
v_fma_f32 v194, v194, s60, v4
v_fma_f32 v195, v195, s60, v4
v_fma_f32 v196, v196, s60, v4
v_fma_f32 v197, v197, s60, v4
v_fma_f32 v198, v198, s60, v4
v_fma_f32 v199, v199, s60, v4
v_fma_f32 v200, v200, s60, v4
v_fma_f32 v201, v201, s60, v4
v_fma_f32 v202, v202, s60, v4
v_fma_f32 v203, v203, s60, v4
v_fma_f32 v204, v204, s60, v4
v_fma_f32 v205, v205, s60, v4
v_fma_f32 v206, v206, s60, v4
v_fma_f32 v207, v207, s60, v4
v_exp_f32 v208, v208
v_exp_f32 v209, v209
v_exp_f32 v210, v210
v_exp_f32 v211, v211
v_exp_f32 v212, v212
v_exp_f32 v213, v213
v_exp_f32 v214, v214
v_exp_f32 v215, v215
v_exp_f32 v216, v216
v_exp_f32 v217, v217
v_exp_f32 v218, v218
v_exp_f32 v219, v219
v_exp_f32 v220, v220
v_exp_f32 v221, v221
v_exp_f32 v222, v222
v_exp_f32 v223, v223
v_exp_f32 v192, v192
v_exp_f32 v193, v193
v_exp_f32 v194, v194
v_exp_f32 v195, v195
v_exp_f32 v196, v196
v_exp_f32 v197, v197
v_exp_f32 v198, v198
v_exp_f32 v199, v199
v_exp_f32 v200, v200
v_exp_f32 v201, v201
v_exp_f32 v202, v202
v_exp_f32 v203, v203
v_exp_f32 v204, v204
v_exp_f32 v205, v205
v_exp_f32 v206, v206
v_exp_f32 v207, v207
s_nop 0
v_cvt_pk_bf16_f32 v104, v208, v209
v_cvt_pk_bf16_f32 v105, v210, v211
v_cvt_pk_bf16_f32 v106, v212, v213
v_cvt_pk_bf16_f32 v107, v214, v215
v_cvt_pk_bf16_f32 v108, v216, v217
v_cvt_pk_bf16_f32 v109, v218, v219
v_cvt_pk_bf16_f32 v110, v220, v221
v_cvt_pk_bf16_f32 v111, v222, v223
v_cvt_pk_bf16_f32 v120, v192, v193
v_cvt_pk_bf16_f32 v121, v194, v195
v_cvt_pk_bf16_f32 v122, v196, v197
v_cvt_pk_bf16_f32 v123, v198, v199
v_cvt_pk_bf16_f32 v124, v200, v201
v_cvt_pk_bf16_f32 v125, v202, v203
v_cvt_pk_bf16_f32 v126, v204, v205
v_cvt_pk_bf16_f32 v127, v206, v207
v_mov_b32 v6, 0x3f803f80
v_mov_b32 v7, 0
v_cndmask_b32 v68, v6, v7, vcc
v_cndmask_b32 v69, v6, v7, vcc
v_cndmask_b32 v70, v6, v7, vcc
v_cndmask_b32 v71, v6, v7, vcc
s_waitcnt lgkmcnt(0)
s_nop 0
v_mfma_f32_32x32x16_bf16 v[208:223], v[232:235], v[104:107], 0
v_mfma_f32_16x16x32_bf16 v[184:187], v[248:251], v[104:107], 0
v_mfma_f32_16x16x32_bf16 v[80:83], v[68:71], v[104:107], 0
v_mfma_f32_32x32x16_bf16 v[208:223], v[236:239], v[108:111], v[208:223]
v_mfma_f32_16x16x32_bf16 v[184:187], v[252:255], v[108:111], v[184:187]
v_mfma_f32_16x16x32_bf16 v[80:83], v[68:71], v[108:111], v[80:83]
v_mfma_f32_32x32x16_bf16 v[192:207], v[224:227], v[120:123], 0
v_mfma_f32_16x16x32_bf16 v[180:183], v[240:243], v[120:123], 0
v_mfma_f32_16x16x32_bf16 v[64:67], v[68:71], v[120:123], 0
v_mfma_f32_32x32x16_bf16 v[192:207], v[228:231], v[124:127], v[192:207]
v_mfma_f32_16x16x32_bf16 v[180:183], v[244:247], v[124:127], v[180:183]
v_mfma_f32_16x16x32_bf16 v[64:67], v[68:71], v[124:127], v[64:67]
s_nop 7
v_rcp_f32 v4, v64
v_rcp_f32 v5, v80
s_nop 0
v_mul_f32 v6, v180, v4
v_fmac_f32 v6, v184, v5
v_add_f32 v6, 0x358637bd, v6
v_rcp_f32 v6, v6
s_nop 0
v_mul_f32 v6, v6, v177
v_mul_f32 v4, v4, v6
v_mul_f32 v5, v5, v6
v_mul_f32 v192, v4, v192
v_mul_f32 v193, v4, v193
v_mul_f32 v194, v4, v194
v_mul_f32 v195, v4, v195
v_mul_f32 v196, v4, v196
v_mul_f32 v197, v4, v197
v_mul_f32 v198, v4, v198
v_mul_f32 v199, v4, v199
v_mul_f32 v200, v4, v200
v_mul_f32 v201, v4, v201
v_mul_f32 v202, v4, v202
v_mul_f32 v203, v4, v203
v_mul_f32 v204, v4, v204
v_mul_f32 v205, v4, v205
v_mul_f32 v206, v4, v206
v_mul_f32 v207, v4, v207
v_fmac_f32 v192, v5, v208
v_fmac_f32 v193, v5, v209
v_fmac_f32 v194, v5, v210
v_fmac_f32 v195, v5, v211
v_fmac_f32 v196, v5, v212
v_fmac_f32 v197, v5, v213
v_fmac_f32 v198, v5, v214
v_fmac_f32 v199, v5, v215
v_fmac_f32 v200, v5, v216
v_fmac_f32 v201, v5, v217
v_fmac_f32 v202, v5, v218
v_fmac_f32 v203, v5, v219
v_fmac_f32 v204, v5, v220
v_fmac_f32 v205, v5, v221
v_fmac_f32 v206, v5, v222
v_fmac_f32 v207, v5, v223
v_cvt_pk_bf16_f32 v224, v192, v193
v_cvt_pk_bf16_f32 v225, v194, v195
v_cvt_pk_bf16_f32 v226, v196, v197
v_cvt_pk_bf16_f32 v227, v198, v199
v_cvt_pk_bf16_f32 v228, v200, v201
v_cvt_pk_bf16_f32 v229, v202, v203
v_cvt_pk_bf16_f32 v230, v204, v205
v_cvt_pk_bf16_f32 v231, v206, v207
s_lshl_b32 s34, s91, 13
s_add_u32 s34, s34, s29
buffer_store_dwordx4 v[224:227], v1, s[12:15], s34 offen sc1
buffer_store_dwordx4 v[228:231], v1, s[12:15], s34 offen offset:1024 sc1
s_mov_b32 s27, 3
s_branch K2_loopB
.p2alignl 6, 0xbf810000
K2_loopB:
s_waitcnt lgkmcnt(0)
v_exp_f32 v88, v88
v_exp_f32 v89, v89
v_smfmac_f32_16x16x64_bf16 v[164:167], v[168:171], v[112:119], v189
ds_read_b128 v[64:67], v2 offset:4096
ds_read_b128 v[68:71], v2 offset:5120
v_exp_f32 v90, v90
v_smfmac_f32_32x32x32_bf16 v[144:159], v[84:87], v[112:119], v189
v_exp_f32 v91, v91
v_exp_f32 v92, v92
v_mfma_f32_32x32x16_bf16 v[104:119], v[56:59], v[16:19], v[40:55]
v_exp_f32 v93, v93
v_exp_f32 v94, v94
v_mfma_f32_32x32x16_bf16 v[104:119], v[60:63], v[20:23], v[104:119]
v_exp_f32 v95, v95
v_exp_f32 v96, v96
v_exp_f32 v97, v97
v_smfmac_f32_16x16x64_bf16 v[160:163], v[168:171], v[88:95], v189
v_exp_f32 v98, v98
v_smfmac_f32_32x32x32_bf16 v[128:143], v[72:75], v[88:95], v189
v_exp_f32 v99, v99
v_exp_f32 v100, v100
v_exp_f32 v101, v101
v_exp_f32 v102, v102
v_exp_f32 v103, v103
s_waitcnt lgkmcnt(0)
v_exp_f32 v104, v104
v_exp_f32 v105, v105
v_smfmac_f32_16x16x64_bf16 v[160:163], v[168:171], v[96:103], v189
ds_read_b128 v[80:83], v2 offset:6144
ds_read_b128 v[84:87], v2 offset:7168
v_exp_f32 v106, v106
v_smfmac_f32_32x32x32_bf16 v[128:143], v[76:79], v[96:103], v189
v_exp_f32 v107, v107
v_exp_f32 v108, v108
v_mfma_f32_32x32x16_bf16 v[88:103], v[64:67], v[8:11], v[24:39]
v_exp_f32 v109, v109
v_exp_f32 v110, v110
v_mfma_f32_32x32x16_bf16 v[88:103], v[68:71], v[12:15], v[88:103]
v_exp_f32 v111, v111
v_exp_f32 v112, v112
v_exp_f32 v113, v113
v_smfmac_f32_16x16x64_bf16 v[164:167], v[168:171], v[104:111], v189
v_exp_f32 v114, v114
v_smfmac_f32_32x32x32_bf16 v[144:159], v[72:75], v[104:111], v189
v_exp_f32 v115, v115
v_exp_f32 v116, v116
v_exp_f32 v117, v117
v_exp_f32 v118, v118
v_exp_f32 v119, v119
s_waitcnt lgkmcnt(0)
v_exp_f32 v88, v88
v_exp_f32 v89, v89
v_smfmac_f32_16x16x64_bf16 v[164:167], v[168:171], v[112:119], v189
ds_read_b128 v[56:59], v2 offset:8192
ds_read_b128 v[60:63], v2 offset:9216
v_exp_f32 v90, v90
v_smfmac_f32_32x32x32_bf16 v[144:159], v[76:79], v[112:119], v189
v_exp_f32 v91, v91
v_exp_f32 v92, v92
v_mfma_f32_32x32x16_bf16 v[104:119], v[64:67], v[16:19], v[40:55]
v_exp_f32 v93, v93
v_exp_f32 v94, v94
v_mfma_f32_32x32x16_bf16 v[104:119], v[68:71], v[20:23], v[104:119]
v_exp_f32 v95, v95
v_exp_f32 v96, v96
v_exp_f32 v97, v97
v_smfmac_f32_16x16x64_bf16 v[160:163], v[168:171], v[88:95], v189
v_exp_f32 v98, v98
v_smfmac_f32_32x32x32_bf16 v[128:143], v[80:83], v[88:95], v189
v_exp_f32 v99, v99
v_exp_f32 v100, v100
v_exp_f32 v101, v101
v_exp_f32 v102, v102
v_exp_f32 v103, v103
s_waitcnt lgkmcnt(0)
v_exp_f32 v104, v104
v_exp_f32 v105, v105
v_smfmac_f32_16x16x64_bf16 v[160:163], v[168:171], v[96:103], v189
ds_read_b128 v[72:75], v2 offset:10240
ds_read_b128 v[76:79], v2 offset:11264
v_exp_f32 v106, v106
v_smfmac_f32_32x32x32_bf16 v[128:143], v[84:87], v[96:103], v189
v_exp_f32 v107, v107
v_exp_f32 v108, v108
v_mfma_f32_32x32x16_bf16 v[88:103], v[56:59], v[8:11], v[24:39]
v_exp_f32 v109, v109
v_exp_f32 v110, v110
v_mfma_f32_32x32x16_bf16 v[88:103], v[60:63], v[12:15], v[88:103]
v_exp_f32 v111, v111
v_exp_f32 v112, v112
v_exp_f32 v113, v113
v_smfmac_f32_16x16x64_bf16 v[164:167], v[168:171], v[104:111], v189
v_exp_f32 v114, v114
v_smfmac_f32_32x32x32_bf16 v[144:159], v[80:83], v[104:111], v189
v_exp_f32 v115, v115
v_exp_f32 v116, v116
v_exp_f32 v117, v117
v_exp_f32 v118, v118
v_exp_f32 v119, v119
s_waitcnt lgkmcnt(0)
v_exp_f32 v88, v88
v_exp_f32 v89, v89
v_smfmac_f32_16x16x64_bf16 v[164:167], v[168:171], v[112:119], v189
ds_read_b128 v[64:67], v2 offset:12288
ds_read_b128 v[68:71], v2 offset:13312
v_exp_f32 v90, v90
v_smfmac_f32_32x32x32_bf16 v[144:159], v[84:87], v[112:119], v189
v_exp_f32 v91, v91
v_exp_f32 v92, v92
v_mfma_f32_32x32x16_bf16 v[104:119], v[56:59], v[16:19], v[40:55]
v_exp_f32 v93, v93
v_exp_f32 v94, v94
v_mfma_f32_32x32x16_bf16 v[104:119], v[60:63], v[20:23], v[104:119]
v_exp_f32 v95, v95
v_exp_f32 v96, v96
v_exp_f32 v97, v97
v_smfmac_f32_16x16x64_bf16 v[160:163], v[168:171], v[88:95], v189
v_exp_f32 v98, v98
v_smfmac_f32_32x32x32_bf16 v[128:143], v[72:75], v[88:95], v189
v_exp_f32 v99, v99
v_exp_f32 v100, v100
v_exp_f32 v101, v101
v_exp_f32 v102, v102
v_exp_f32 v103, v103
s_waitcnt lgkmcnt(0)
v_exp_f32 v104, v104
v_exp_f32 v105, v105
v_smfmac_f32_16x16x64_bf16 v[160:163], v[168:171], v[96:103], v189
ds_read_b128 v[80:83], v2 offset:14336
ds_read_b128 v[84:87], v2 offset:15360
v_exp_f32 v106, v106
v_smfmac_f32_32x32x32_bf16 v[128:143], v[76:79], v[96:103], v189
v_exp_f32 v107, v107
v_exp_f32 v108, v108
v_mfma_f32_32x32x16_bf16 v[88:103], v[64:67], v[8:11], v[24:39]
v_exp_f32 v109, v109
v_exp_f32 v110, v110
v_mfma_f32_32x32x16_bf16 v[88:103], v[68:71], v[12:15], v[88:103]
v_exp_f32 v111, v111
v_exp_f32 v112, v112
v_exp_f32 v113, v113
v_smfmac_f32_16x16x64_bf16 v[164:167], v[168:171], v[104:111], v189
v_exp_f32 v114, v114
v_smfmac_f32_32x32x32_bf16 v[144:159], v[72:75], v[104:111], v189
v_exp_f32 v115, v115
v_exp_f32 v116, v116
v_exp_f32 v117, v117
v_exp_f32 v118, v118
v_exp_f32 v119, v119
s_waitcnt lgkmcnt(0)
s_waitcnt vmcnt(0)
s_barrier
v_exp_f32 v88, v88
v_exp_f32 v89, v89
v_smfmac_f32_16x16x64_bf16 v[164:167], v[168:171], v[112:119], v189
ds_read_b128 v[56:59], v3 offset:0
ds_read_b128 v[60:63], v3 offset:1024
v_exp_f32 v90, v90
v_smfmac_f32_32x32x32_bf16 v[144:159], v[76:79], v[112:119], v189
s_mov_b32 m0, s25
s_nop 0
buffer_load_dwordx4 v190, s[12:15], s24 offen offset:0 sc1 lds
buffer_load_dwordx4 v190, s[12:15], s24 offen offset:1024 sc1 lds
buffer_load_dwordx4 v190, s[12:15], s24 offen offset:2048 sc1 lds
buffer_load_dwordx4 v190, s[12:15], s24 offen offset:3072 sc1 lds
s_add_u32 s24, s24, 32768
s_and_b32 s24, s24, 0x3ffff
s_add_u32 s25, s25, 32768
s_sub_u32 s34, s25, 98304
s_min_u32 s25, s25, s34
s_cmp_eq_u32 s27, s28
s_cbranch_scc0 K2_nofl
v_mov_b32 v4, 1
s_mov_b64 exec, 1
buffer_store_dword v4, off, s[12:15], s32 sc1
s_mov_b64 exec, -1
K2_nofl:
v_exp_f32 v91, v91
v_exp_f32 v92, v92
v_mfma_f32_32x32x16_bf16 v[104:119], v[64:67], v[16:19], v[40:55]
v_exp_f32 v93, v93
v_exp_f32 v94, v94
v_mfma_f32_32x32x16_bf16 v[104:119], v[68:71], v[20:23], v[104:119]
v_exp_f32 v95, v95
v_exp_f32 v96, v96
v_exp_f32 v97, v97
v_smfmac_f32_16x16x64_bf16 v[160:163], v[168:171], v[88:95], v189
v_exp_f32 v98, v98
v_smfmac_f32_32x32x32_bf16 v[128:143], v[80:83], v[88:95], v189
v_exp_f32 v99, v99
v_exp_f32 v100, v100
v_exp_f32 v101, v101
v_exp_f32 v102, v102
v_exp_f32 v103, v103
s_waitcnt lgkmcnt(0)
v_exp_f32 v104, v104
v_exp_f32 v105, v105
v_smfmac_f32_16x16x64_bf16 v[160:163], v[168:171], v[96:103], v189
ds_read_b128 v[72:75], v3 offset:2048
ds_read_b128 v[76:79], v3 offset:3072
v_exp_f32 v106, v106
v_smfmac_f32_32x32x32_bf16 v[128:143], v[84:87], v[96:103], v189
v_exp_f32 v107, v107
v_exp_f32 v108, v108
v_mfma_f32_32x32x16_bf16 v[88:103], v[56:59], v[8:11], v[24:39]
v_exp_f32 v109, v109
v_exp_f32 v110, v110
v_mfma_f32_32x32x16_bf16 v[88:103], v[60:63], v[12:15], v[88:103]
v_exp_f32 v111, v111
v_exp_f32 v112, v112
v_exp_f32 v113, v113
v_smfmac_f32_16x16x64_bf16 v[164:167], v[168:171], v[104:111], v189
v_exp_f32 v114, v114
v_smfmac_f32_32x32x32_bf16 v[144:159], v[80:83], v[104:111], v189
v_exp_f32 v115, v115
v_exp_f32 v116, v116
v_exp_f32 v117, v117
v_exp_f32 v118, v118
v_exp_f32 v119, v119
v_mov_b32 v2, v3
s_add_u32 s26, s26, 32768
s_sub_u32 s34, s26, 98304
s_min_u32 s26, s26, s34
v_add_u32 v3, s26, v1
s_sub_u32 s27, s27, 1
s_cmp_lg_u32 s27, 0
s_cbranch_scc1 K2_loopB
s_waitcnt lgkmcnt(0)
v_exp_f32 v88, v88
v_exp_f32 v89, v89
v_smfmac_f32_16x16x64_bf16 v[164:167], v[168:171], v[112:119], v189
ds_read_b128 v[64:67], v2 offset:4096
ds_read_b128 v[68:71], v2 offset:5120
v_exp_f32 v90, v90
v_smfmac_f32_32x32x32_bf16 v[144:159], v[84:87], v[112:119], v189
buffer_load_dword v178, v179, s[12:15], s33 offen sc1
v_exp_f32 v91, v91
v_exp_f32 v92, v92
v_mfma_f32_32x32x16_bf16 v[104:119], v[56:59], v[16:19], v[40:55]
v_exp_f32 v93, v93
v_exp_f32 v94, v94
v_mfma_f32_32x32x16_bf16 v[104:119], v[60:63], v[20:23], v[104:119]
v_exp_f32 v95, v95
v_exp_f32 v96, v96
v_exp_f32 v97, v97
v_smfmac_f32_16x16x64_bf16 v[160:163], v[168:171], v[88:95], v189
v_exp_f32 v98, v98
v_smfmac_f32_32x32x32_bf16 v[128:143], v[72:75], v[88:95], v189
v_exp_f32 v99, v99
v_exp_f32 v100, v100
v_exp_f32 v101, v101
v_exp_f32 v102, v102
v_exp_f32 v103, v103
s_waitcnt lgkmcnt(0)
v_exp_f32 v104, v104
v_exp_f32 v105, v105
v_smfmac_f32_16x16x64_bf16 v[160:163], v[168:171], v[96:103], v189
ds_read_b128 v[80:83], v2 offset:6144
ds_read_b128 v[84:87], v2 offset:7168
v_exp_f32 v106, v106
v_smfmac_f32_32x32x32_bf16 v[128:143], v[76:79], v[96:103], v189
v_exp_f32 v107, v107
v_exp_f32 v108, v108
v_mfma_f32_32x32x16_bf16 v[88:103], v[64:67], v[8:11], v[24:39]
v_exp_f32 v109, v109
v_exp_f32 v110, v110
v_mfma_f32_32x32x16_bf16 v[88:103], v[68:71], v[12:15], v[88:103]
v_exp_f32 v111, v111
v_exp_f32 v112, v112
v_exp_f32 v113, v113
v_smfmac_f32_16x16x64_bf16 v[164:167], v[168:171], v[104:111], v189
v_exp_f32 v114, v114
v_smfmac_f32_32x32x32_bf16 v[144:159], v[72:75], v[104:111], v189
v_exp_f32 v115, v115
v_exp_f32 v116, v116
v_exp_f32 v117, v117
v_exp_f32 v118, v118
v_exp_f32 v119, v119
s_waitcnt lgkmcnt(0)
v_exp_f32 v88, v88
v_exp_f32 v89, v89
v_smfmac_f32_16x16x64_bf16 v[164:167], v[168:171], v[112:119], v189
ds_read_b128 v[56:59], v2 offset:8192
ds_read_b128 v[60:63], v2 offset:9216
v_exp_f32 v90, v90
v_smfmac_f32_32x32x32_bf16 v[144:159], v[76:79], v[112:119], v189
v_exp_f32 v91, v91
v_exp_f32 v92, v92
v_mfma_f32_32x32x16_bf16 v[104:119], v[64:67], v[16:19], v[40:55]
v_exp_f32 v93, v93
v_exp_f32 v94, v94
v_mfma_f32_32x32x16_bf16 v[104:119], v[68:71], v[20:23], v[104:119]
v_exp_f32 v95, v95
v_exp_f32 v96, v96
v_exp_f32 v97, v97
v_smfmac_f32_16x16x64_bf16 v[160:163], v[168:171], v[88:95], v189
v_exp_f32 v98, v98
v_smfmac_f32_32x32x32_bf16 v[128:143], v[80:83], v[88:95], v189
v_exp_f32 v99, v99
v_exp_f32 v100, v100
v_exp_f32 v101, v101
v_exp_f32 v102, v102
v_exp_f32 v103, v103
s_waitcnt lgkmcnt(0)
v_exp_f32 v104, v104
v_exp_f32 v105, v105
v_smfmac_f32_16x16x64_bf16 v[160:163], v[168:171], v[96:103], v189
ds_read_b128 v[72:75], v2 offset:10240
ds_read_b128 v[76:79], v2 offset:11264
v_exp_f32 v106, v106
v_smfmac_f32_32x32x32_bf16 v[128:143], v[84:87], v[96:103], v189
v_exp_f32 v107, v107
v_exp_f32 v108, v108
v_mfma_f32_32x32x16_bf16 v[88:103], v[56:59], v[8:11], v[24:39]
v_exp_f32 v109, v109
v_exp_f32 v110, v110
v_mfma_f32_32x32x16_bf16 v[88:103], v[60:63], v[12:15], v[88:103]
v_exp_f32 v111, v111
v_exp_f32 v112, v112
v_exp_f32 v113, v113
v_smfmac_f32_16x16x64_bf16 v[164:167], v[168:171], v[104:111], v189
v_exp_f32 v114, v114
v_smfmac_f32_32x32x32_bf16 v[144:159], v[80:83], v[104:111], v189
v_exp_f32 v115, v115
v_exp_f32 v116, v116
v_exp_f32 v117, v117
v_exp_f32 v118, v118
v_exp_f32 v119, v119
s_waitcnt lgkmcnt(0)
v_exp_f32 v88, v88
v_exp_f32 v89, v89
v_smfmac_f32_16x16x64_bf16 v[164:167], v[168:171], v[112:119], v189
ds_read_b128 v[64:67], v2 offset:12288
ds_read_b128 v[68:71], v2 offset:13312
v_exp_f32 v90, v90
v_smfmac_f32_32x32x32_bf16 v[144:159], v[84:87], v[112:119], v189
v_exp_f32 v91, v91
v_exp_f32 v92, v92
v_mfma_f32_32x32x16_bf16 v[104:119], v[56:59], v[16:19], v[40:55]
v_exp_f32 v93, v93
v_exp_f32 v94, v94
v_mfma_f32_32x32x16_bf16 v[104:119], v[60:63], v[20:23], v[104:119]
v_exp_f32 v95, v95
v_exp_f32 v96, v96
v_exp_f32 v97, v97
v_smfmac_f32_16x16x64_bf16 v[160:163], v[168:171], v[88:95], v189
v_exp_f32 v98, v98
v_smfmac_f32_32x32x32_bf16 v[128:143], v[72:75], v[88:95], v189
v_exp_f32 v99, v99
v_exp_f32 v100, v100
v_exp_f32 v101, v101
v_exp_f32 v102, v102
v_exp_f32 v103, v103
s_waitcnt lgkmcnt(0)
v_exp_f32 v104, v104
v_exp_f32 v105, v105
v_smfmac_f32_16x16x64_bf16 v[160:163], v[168:171], v[96:103], v189
ds_read_b128 v[80:83], v2 offset:14336
ds_read_b128 v[84:87], v2 offset:15360
v_exp_f32 v106, v106
v_smfmac_f32_32x32x32_bf16 v[128:143], v[76:79], v[96:103], v189
v_exp_f32 v107, v107
v_exp_f32 v108, v108
v_mfma_f32_32x32x16_bf16 v[88:103], v[64:67], v[8:11], v[24:39]
v_exp_f32 v109, v109
v_exp_f32 v110, v110
v_mfma_f32_32x32x16_bf16 v[88:103], v[68:71], v[12:15], v[88:103]
v_exp_f32 v111, v111
v_exp_f32 v112, v112
v_exp_f32 v113, v113
v_smfmac_f32_16x16x64_bf16 v[164:167], v[168:171], v[104:111], v189
v_exp_f32 v114, v114
v_smfmac_f32_32x32x32_bf16 v[144:159], v[72:75], v[104:111], v189
v_exp_f32 v115, v115
v_exp_f32 v116, v116
v_exp_f32 v117, v117
v_exp_f32 v118, v118
v_exp_f32 v119, v119
s_waitcnt lgkmcnt(0)
s_waitcnt vmcnt(0)
v_cmp_ne_u32 vcc, 1, v178
s_barrier
s_cbranch_vccnz K2_spinA
K2_spinA_b:
v_exp_f32 v88, v88
v_exp_f32 v89, v89
v_smfmac_f32_16x16x64_bf16 v[164:167], v[168:171], v[112:119], v189
ds_read_b128 v[56:59], v3 offset:0
ds_read_b128 v[60:63], v3 offset:1024
v_exp_f32 v90, v90
v_smfmac_f32_32x32x32_bf16 v[144:159], v[76:79], v[112:119], v189
s_add_u32 m0, s66, 0
s_nop 0
s_add_u32 s59, s67, 0
buffer_load_dwordx4 v173, s[4:7], s59 offen lds
buffer_load_dwordx4 v[192:195], v172, s[12:15], s68 offen sc1
buffer_load_dwordx4 v[196:199], v172, s[12:15], s68 offen offset:256 sc1
s_add_u32 s68, s68, 16384
v_exp_f32 v91, v91
v_exp_f32 v92, v92
v_mfma_f32_32x32x16_bf16 v[104:119], v[64:67], v[16:19], v[40:55]
v_exp_f32 v93, v93
v_exp_f32 v94, v94
v_mfma_f32_32x32x16_bf16 v[104:119], v[68:71], v[20:23], v[104:119]
v_exp_f32 v95, v95
v_exp_f32 v96, v96
v_exp_f32 v97, v97
v_smfmac_f32_16x16x64_bf16 v[160:163], v[168:171], v[88:95], v189
v_exp_f32 v98, v98
v_smfmac_f32_32x32x32_bf16 v[128:143], v[80:83], v[88:95], v189
v_exp_f32 v99, v99
v_exp_f32 v100, v100
v_exp_f32 v101, v101
v_exp_f32 v102, v102
v_exp_f32 v103, v103
s_waitcnt lgkmcnt(0)
v_exp_f32 v104, v104
v_exp_f32 v105, v105
v_smfmac_f32_16x16x64_bf16 v[160:163], v[168:171], v[96:103], v189
ds_read_b128 v[72:75], v3 offset:2048
ds_read_b128 v[76:79], v3 offset:3072
v_exp_f32 v106, v106
v_smfmac_f32_32x32x32_bf16 v[128:143], v[84:87], v[96:103], v189
s_add_u32 m0, s66, 4096
s_nop 0
s_add_u32 s59, s67, 131072
buffer_load_dwordx4 v173, s[4:7], s59 offen lds
buffer_load_dwordx4 v[200:203], v172, s[12:15], s68 offen sc1
buffer_load_dwordx4 v[204:207], v172, s[12:15], s68 offen offset:256 sc1
s_add_u32 s68, s68, 16384
v_exp_f32 v107, v107
v_exp_f32 v108, v108
v_mfma_f32_32x32x16_bf16 v[88:103], v[56:59], v[8:11], v[24:39]
v_exp_f32 v109, v109
v_exp_f32 v110, v110
v_mfma_f32_32x32x16_bf16 v[88:103], v[60:63], v[12:15], v[88:103]
v_exp_f32 v111, v111
v_exp_f32 v112, v112
v_exp_f32 v113, v113
v_smfmac_f32_16x16x64_bf16 v[164:167], v[168:171], v[104:111], v189
v_exp_f32 v114, v114
v_smfmac_f32_32x32x32_bf16 v[144:159], v[80:83], v[104:111], v189
v_exp_f32 v115, v115
v_exp_f32 v116, v116
v_exp_f32 v117, v117
v_exp_f32 v118, v118
v_exp_f32 v119, v119
v_mov_b32 v2, v3
s_add_u32 s26, s26, 32768
s_sub_u32 s34, s26, 98304
s_min_u32 s26, s26, s34
v_add_u32 v3, s26, v1
s_waitcnt lgkmcnt(0)
v_exp_f32 v88, v88
v_exp_f32 v89, v89
v_smfmac_f32_16x16x64_bf16 v[164:167], v[168:171], v[112:119], v189
ds_read_b128 v[64:67], v2 offset:4096
ds_read_b128 v[68:71], v2 offset:5120
v_exp_f32 v90, v90
v_smfmac_f32_32x32x32_bf16 v[144:159], v[84:87], v[112:119], v189
s_add_u32 m0, s66, 8192
s_nop 0
s_add_u32 s59, s67, 262144
buffer_load_dwordx4 v173, s[4:7], s59 offen lds
buffer_load_dwordx4 v[208:211], v172, s[12:15], s68 offen sc1
buffer_load_dwordx4 v[212:215], v172, s[12:15], s68 offen offset:256 sc1
s_add_u32 s68, s68, 16384
v_exp_f32 v91, v91
v_exp_f32 v92, v92
v_mfma_f32_32x32x16_bf16 v[104:119], v[56:59], v[16:19], v[40:55]
v_exp_f32 v93, v93
v_exp_f32 v94, v94
v_mfma_f32_32x32x16_bf16 v[104:119], v[60:63], v[20:23], v[104:119]
v_exp_f32 v95, v95
v_exp_f32 v96, v96
v_exp_f32 v97, v97
v_smfmac_f32_16x16x64_bf16 v[160:163], v[168:171], v[88:95], v189
v_exp_f32 v98, v98
v_smfmac_f32_32x32x32_bf16 v[128:143], v[72:75], v[88:95], v189
v_exp_f32 v99, v99
v_exp_f32 v100, v100
v_exp_f32 v101, v101
v_exp_f32 v102, v102
v_exp_f32 v103, v103
s_waitcnt lgkmcnt(0)
v_exp_f32 v104, v104
v_exp_f32 v105, v105
v_smfmac_f32_16x16x64_bf16 v[160:163], v[168:171], v[96:103], v189
ds_read_b128 v[80:83], v2 offset:6144
ds_read_b128 v[84:87], v2 offset:7168
v_exp_f32 v106, v106
v_smfmac_f32_32x32x32_bf16 v[128:143], v[76:79], v[96:103], v189
s_add_u32 m0, s66, 12288
s_nop 0
s_add_u32 s59, s67, 393216
buffer_load_dwordx4 v173, s[4:7], s59 offen lds
buffer_load_dwordx4 v[216:219], v172, s[12:15], s68 offen sc1
buffer_load_dwordx4 v[220:223], v172, s[12:15], s68 offen offset:256 sc1
s_add_u32 s68, s68, 16384
v_exp_f32 v107, v107
v_exp_f32 v108, v108
v_mfma_f32_32x32x16_bf16 v[88:103], v[64:67], v[8:11], v[24:39]
v_exp_f32 v109, v109
v_exp_f32 v110, v110
v_mfma_f32_32x32x16_bf16 v[88:103], v[68:71], v[12:15], v[88:103]
v_exp_f32 v111, v111
v_exp_f32 v112, v112
v_exp_f32 v113, v113
v_smfmac_f32_16x16x64_bf16 v[164:167], v[168:171], v[104:111], v189
v_exp_f32 v114, v114
v_smfmac_f32_32x32x32_bf16 v[144:159], v[72:75], v[104:111], v189
v_exp_f32 v115, v115
v_exp_f32 v116, v116
v_exp_f32 v117, v117
v_exp_f32 v118, v118
v_exp_f32 v119, v119
s_waitcnt lgkmcnt(0)
v_exp_f32 v88, v88
v_exp_f32 v89, v89
v_smfmac_f32_16x16x64_bf16 v[164:167], v[168:171], v[112:119], v189
ds_read_b128 v[56:59], v2 offset:8192
ds_read_b128 v[60:63], v2 offset:9216
v_exp_f32 v90, v90
v_smfmac_f32_32x32x32_bf16 v[144:159], v[76:79], v[112:119], v189
s_add_u32 m0, s66, 65536
s_nop 0
s_add_u32 s59, s67, 524288
buffer_load_dwordx4 v173, s[4:7], s59 offen lds
buffer_load_dwordx4 v[224:227], v172, s[12:15], s68 offen sc1
buffer_load_dwordx4 v[228:231], v172, s[12:15], s68 offen offset:256 sc1
s_add_u32 s68, s68, 16384
v_exp_f32 v91, v91
v_exp_f32 v92, v92
v_mfma_f32_32x32x16_bf16 v[104:119], v[64:67], v[16:19], v[40:55]
v_exp_f32 v93, v93
v_exp_f32 v94, v94
v_mfma_f32_32x32x16_bf16 v[104:119], v[68:71], v[20:23], v[104:119]
v_exp_f32 v95, v95
v_exp_f32 v96, v96
v_exp_f32 v97, v97
v_smfmac_f32_16x16x64_bf16 v[160:163], v[168:171], v[88:95], v189
v_exp_f32 v98, v98
v_smfmac_f32_32x32x32_bf16 v[128:143], v[80:83], v[88:95], v189
v_exp_f32 v99, v99
v_exp_f32 v100, v100
v_exp_f32 v101, v101
v_exp_f32 v102, v102
v_exp_f32 v103, v103
s_waitcnt lgkmcnt(0)
v_exp_f32 v104, v104
v_exp_f32 v105, v105
v_smfmac_f32_16x16x64_bf16 v[160:163], v[168:171], v[96:103], v189
ds_read_b128 v[72:75], v2 offset:10240
ds_read_b128 v[76:79], v2 offset:11264
v_exp_f32 v106, v106
v_smfmac_f32_32x32x32_bf16 v[128:143], v[84:87], v[96:103], v189
s_add_u32 m0, s66, 69632
s_nop 0
s_add_u32 s59, s67, 655360
buffer_load_dwordx4 v173, s[4:7], s59 offen lds
buffer_load_dwordx4 v[232:235], v172, s[12:15], s68 offen sc1
buffer_load_dwordx4 v[236:239], v172, s[12:15], s68 offen offset:256 sc1
s_add_u32 s68, s68, 16384
v_exp_f32 v107, v107
v_exp_f32 v108, v108
v_mfma_f32_32x32x16_bf16 v[88:103], v[56:59], v[8:11], v[24:39]
v_exp_f32 v109, v109
v_exp_f32 v110, v110
v_mfma_f32_32x32x16_bf16 v[88:103], v[60:63], v[12:15], v[88:103]
v_exp_f32 v111, v111
v_exp_f32 v112, v112
v_exp_f32 v113, v113
v_smfmac_f32_16x16x64_bf16 v[164:167], v[168:171], v[104:111], v189
v_exp_f32 v114, v114
v_smfmac_f32_32x32x32_bf16 v[144:159], v[80:83], v[104:111], v189
v_exp_f32 v115, v115
v_exp_f32 v116, v116
v_exp_f32 v117, v117
v_exp_f32 v118, v118
v_exp_f32 v119, v119
s_waitcnt lgkmcnt(0)
v_exp_f32 v88, v88
v_exp_f32 v89, v89
v_smfmac_f32_16x16x64_bf16 v[164:167], v[168:171], v[112:119], v189
ds_read_b128 v[64:67], v2 offset:12288
ds_read_b128 v[68:71], v2 offset:13312
v_exp_f32 v90, v90
v_smfmac_f32_32x32x32_bf16 v[144:159], v[84:87], v[112:119], v189
s_add_u32 m0, s66, 73728
s_nop 0
s_add_u32 s59, s67, 786432
buffer_load_dwordx4 v173, s[4:7], s59 offen lds
buffer_load_dwordx4 v[240:243], v172, s[12:15], s68 offen sc1
buffer_load_dwordx4 v[244:247], v172, s[12:15], s68 offen offset:256 sc1
s_add_u32 s68, s68, 16384
v_exp_f32 v91, v91
v_exp_f32 v92, v92
v_mfma_f32_32x32x16_bf16 v[104:119], v[56:59], v[16:19], v[40:55]
v_exp_f32 v93, v93
v_exp_f32 v94, v94
v_mfma_f32_32x32x16_bf16 v[104:119], v[60:63], v[20:23], v[104:119]
v_exp_f32 v95, v95
v_exp_f32 v96, v96
v_exp_f32 v97, v97
v_smfmac_f32_16x16x64_bf16 v[160:163], v[168:171], v[88:95], v189
v_exp_f32 v98, v98
v_smfmac_f32_32x32x32_bf16 v[128:143], v[72:75], v[88:95], v189
v_exp_f32 v99, v99
v_exp_f32 v100, v100
v_exp_f32 v101, v101
v_exp_f32 v102, v102
v_exp_f32 v103, v103
s_waitcnt lgkmcnt(0)
v_exp_f32 v104, v104
v_exp_f32 v105, v105
v_smfmac_f32_16x16x64_bf16 v[160:163], v[168:171], v[96:103], v189
ds_read_b128 v[80:83], v2 offset:14336
ds_read_b128 v[84:87], v2 offset:15360
v_exp_f32 v106, v106
v_smfmac_f32_32x32x32_bf16 v[128:143], v[76:79], v[96:103], v189
s_add_u32 m0, s66, 77824
s_nop 0
s_add_u32 s59, s67, 917504
buffer_load_dwordx4 v173, s[4:7], s59 offen lds
buffer_load_dwordx4 v[248:251], v172, s[12:15], s68 offen sc1
buffer_load_dwordx4 v[252:255], v172, s[12:15], s68 offen offset:256 sc1
s_add_u32 s68, s68, 16384
v_exp_f32 v107, v107
v_exp_f32 v108, v108
v_mfma_f32_32x32x16_bf16 v[88:103], v[64:67], v[8:11], v[24:39]
v_exp_f32 v109, v109
v_exp_f32 v110, v110
v_mfma_f32_32x32x16_bf16 v[88:103], v[68:71], v[12:15], v[88:103]
v_exp_f32 v111, v111
v_exp_f32 v112, v112
v_exp_f32 v113, v113
v_smfmac_f32_16x16x64_bf16 v[164:167], v[168:171], v[104:111], v189
v_exp_f32 v114, v114
v_smfmac_f32_32x32x32_bf16 v[144:159], v[72:75], v[104:111], v189
v_exp_f32 v115, v115
v_exp_f32 v116, v116
v_exp_f32 v117, v117
v_exp_f32 v118, v118
v_exp_f32 v119, v119
s_waitcnt lgkmcnt(0)
v_exp_f32 v88, v88
v_exp_f32 v89, v89
v_smfmac_f32_16x16x64_bf16 v[164:167], v[168:171], v[112:119], v189
v_exp_f32 v90, v90
v_smfmac_f32_32x32x32_bf16 v[144:159], v[76:79], v[112:119], v189
v_exp_f32 v91, v91
v_exp_f32 v92, v92
v_mfma_f32_32x32x16_bf16 v[104:119], v[64:67], v[16:19], v[40:55]
v_exp_f32 v93, v93
v_exp_f32 v94, v94
v_mfma_f32_32x32x16_bf16 v[104:119], v[68:71], v[20:23], v[104:119]
v_exp_f32 v95, v95
v_exp_f32 v96, v96
v_exp_f32 v97, v97
v_smfmac_f32_16x16x64_bf16 v[160:163], v[168:171], v[88:95], v189
v_exp_f32 v98, v98
v_smfmac_f32_32x32x32_bf16 v[128:143], v[80:83], v[88:95], v189
v_exp_f32 v99, v99
v_exp_f32 v100, v100
v_exp_f32 v101, v101
v_exp_f32 v102, v102
v_exp_f32 v103, v103
s_waitcnt lgkmcnt(0)
v_exp_f32 v104, v104
v_exp_f32 v105, v105
v_smfmac_f32_16x16x64_bf16 v[160:163], v[168:171], v[96:103], v189
v_exp_f32 v106, v106
v_smfmac_f32_32x32x32_bf16 v[128:143], v[84:87], v[96:103], v189
buffer_load_dwordx4 v[88:91], v172, s[12:15], s68 offen sc1
buffer_load_dwordx4 v[92:95], v172, s[12:15], s68 offen offset:256 sc1
s_add_u32 s68, s68, 16384
buffer_load_dwordx4 v[96:99], v172, s[12:15], s68 offen sc1
buffer_load_dwordx4 v[100:103], v172, s[12:15], s68 offen offset:256 sc1
s_add_u32 s68, s68, 16384
v_exp_f32 v107, v107
v_exp_f32 v108, v108
v_exp_f32 v109, v109
v_exp_f32 v110, v110
v_exp_f32 v111, v111
v_exp_f32 v112, v112
v_exp_f32 v113, v113
v_smfmac_f32_16x16x64_bf16 v[164:167], v[168:171], v[104:111], v189
v_exp_f32 v114, v114
v_smfmac_f32_32x32x32_bf16 v[144:159], v[80:83], v[104:111], v189
v_exp_f32 v115, v115
v_exp_f32 v116, v116
v_exp_f32 v117, v117
v_exp_f32 v118, v118
v_exp_f32 v119, v119
s_lshl_b32 s34, s20, 12
s_add_u32 s34, s34, 131072
v_add_u32 v6, s34, v1
s_lshl_b32 s35, s20, 8
s_add_u32 s35, s35, 126976
v_lshlrev_b32 v5, 2, v0
v_add_u32 v7, s35, v5
s_nop 0
v_smfmac_f32_32x32x32_bf16 v[144:159], v[84:87], v[112:119], v189
v_smfmac_f32_16x16x64_bf16 v[164:167], v[168:171], v[112:119], v189
s_cmp_eq_u32 s23, 0
s_cbranch_scc0 K2_x1
s_nop 7
s_nop 0
ds_write_b128 v6, v[144:147] offset:0
ds_write_b128 v6, v[148:151] offset:1024
ds_write_b128 v6, v[152:155] offset:2048
ds_write_b128 v6, v[156:159] offset:3072
ds_write_b32 v7, v164
s_branch K2_xj
K2_x1:
ds_write_b128 v6, v[128:131] offset:0
ds_write_b128 v6, v[132:135] offset:1024
ds_write_b128 v6, v[136:139] offset:2048
ds_write_b128 v6, v[140:143] offset:3072
ds_write_b32 v7, v160
s_waitcnt lgkmcnt(0)
s_nop 2
v_mov_b32 v128, v144
v_mov_b32 v129, v145
v_mov_b32 v130, v146
v_mov_b32 v131, v147
v_mov_b32 v132, v148
v_mov_b32 v133, v149
v_mov_b32 v134, v150
v_mov_b32 v135, v151
v_mov_b32 v136, v152
v_mov_b32 v137, v153
v_mov_b32 v138, v154
v_mov_b32 v139, v155
v_mov_b32 v140, v156
v_mov_b32 v141, v157
v_mov_b32 v142, v158
v_mov_b32 v143, v159
v_mov_b32 v160, v164
K2_xj:
s_xor_b32 s34, s34, 16384
s_xor_b32 s35, s35, 1024
v_add_u32 v6, s34, v1
v_add_u32 v7, s35, v5
s_waitcnt vmcnt(18) lgkmcnt(0)
s_barrier
ds_read_b128 v[56:59], v6 offset:0
ds_read_b128 v[60:63], v6 offset:1024
ds_read_b128 v[64:67], v6 offset:2048
ds_read_b128 v[68:71], v6 offset:3072
ds_read_b32 v4, v7
s_add_u32 m0, s66, 32768
s_nop 0
s_add_u32 s59, s67, 1048576
buffer_load_dwordx4 v173, s[4:7], s59 offen lds
s_add_u32 m0, s66, 36864
s_nop 0
s_add_u32 s59, s67, 1179648
buffer_load_dwordx4 v173, s[4:7], s59 offen lds
s_waitcnt lgkmcnt(0)
v_pk_add_f32 v[128:129], v[128:129], v[56:57]
v_pk_add_f32 v[130:131], v[130:131], v[58:59]
v_pk_add_f32 v[132:133], v[132:133], v[60:61]
v_pk_add_f32 v[134:135], v[134:135], v[62:63]
v_pk_add_f32 v[136:137], v[136:137], v[64:65]
v_pk_add_f32 v[138:139], v[138:139], v[66:67]
v_pk_add_f32 v[140:141], v[140:141], v[68:69]
v_pk_add_f32 v[142:143], v[142:143], v[70:71]
v_add_f32 v160, v160, v4
v_add_f32_e64 v4, |v128|, |v129|
v_add_f32_e64 v5, |v130|, |v131|
v_add_f32_e64 v4, v4, |v132|
v_add_f32_e64 v5, v5, |v133|
v_add_f32_e64 v4, v4, |v134|
v_add_f32_e64 v5, v5, |v135|
v_add_f32_e64 v4, v4, |v136|
v_add_f32_e64 v5, v5, |v137|
v_add_f32_e64 v4, v4, |v138|
v_add_f32_e64 v5, v5, |v139|
v_add_f32_e64 v4, v4, |v140|
v_add_f32_e64 v5, v5, |v141|
v_add_f32_e64 v4, v4, |v142|
v_add_f32_e64 v5, v5, |v143|
v_add_f32 v4, v4, v5
s_mov_b32 s34, 0x76800000
s_mov_b32 s35, 0x7d800000
v_cmp_ngt_f32 s[36:37], s34, v160
v_cmp_ngt_f32 s[38:39], s35, v4
s_mov_b32 s34, 0x8800000
v_cmp_nlt_f32 vcc, s34, v4
s_nop 1
s_or_b64 s[36:37], s[36:37], s[38:39]
s_or_b64 vcc, vcc, s[36:37]
s_cbranch_vccnz K2_fallback
K2_fin:
v_add_u32 v189, 0x10000, v174
ds_read_b64_tr_b16 v[24:25], v174 offset:0
ds_read_b64_tr_b16 v[26:27], v174 offset:256
ds_read_b64_tr_b16 v[28:29], v175 offset:0
ds_read_b64_tr_b16 v[30:31], v175 offset:256
ds_read_b64_tr_b16 v[32:33], v174 offset:512
ds_read_b64_tr_b16 v[34:35], v174 offset:768
ds_read_b64_tr_b16 v[36:37], v175 offset:512
ds_read_b64_tr_b16 v[38:39], v175 offset:768
v_rcp_f32 v4, v160
v_sub_f32 v5, 1.0, v177
s_nop 0
v_mul_f32 v4, v4, v5
v_mul_f32 v128, v4, v128
v_mul_f32 v129, v4, v129
v_mul_f32 v130, v4, v130
v_mul_f32 v131, v4, v131
v_mul_f32 v132, v4, v132
v_mul_f32 v133, v4, v133
v_mul_f32 v134, v4, v134
v_mul_f32 v135, v4, v135
v_mul_f32 v136, v4, v136
v_mul_f32 v137, v4, v137
v_mul_f32 v138, v4, v138
v_mul_f32 v139, v4, v139
v_mul_f32 v140, v4, v140
v_mul_f32 v141, v4, v141
v_mul_f32 v142, v4, v142
v_mul_f32 v143, v4, v143
v_cvt_pk_bf16_f32 v120, v128, v129
v_cvt_pk_bf16_f32 v121, v130, v131
v_cvt_pk_bf16_f32 v122, v132, v133
v_cvt_pk_bf16_f32 v123, v134, v135
v_cvt_pk_bf16_f32 v124, v136, v137
v_cvt_pk_bf16_f32 v125, v138, v139
v_cvt_pk_bf16_f32 v126, v140, v141
v_cvt_pk_bf16_f32 v127, v142, v143
s_add_u32 s34, s29, 262144
buffer_store_dwordx4 v[120:123], v1, s[12:15], s34 offen sc1
buffer_store_dwordx4 v[124:127], v1, s[12:15], s34 offen offset:1024 sc1
s_waitcnt vmcnt(29) lgkmcnt(0)
v_mfma_f32_16x16x32_bf16 v[56:59], v[24:27], v[192:195], 0
ds_read_b64_tr_b16 v[40:41], v174 offset:4096
v_mfma_f32_16x16x32_bf16 v[72:75], v[24:27], v[196:199], 0
ds_read_b64_tr_b16 v[42:43], v174 offset:4352
buffer_load_dwordx4 v[104:107], v172, s[12:15], s68 offen sc1
buffer_load_dwordx4 v[108:111], v172, s[12:15], s68 offen offset:256 sc1
s_add_u32 s68, s68, 16384
v_mfma_f32_16x16x32_bf16 v[60:63], v[28:31], v[192:195], 0
ds_read_b64_tr_b16 v[44:45], v175 offset:4096
v_mfma_f32_16x16x32_bf16 v[76:79], v[28:31], v[196:199], 0
ds_read_b64_tr_b16 v[46:47], v175 offset:4352
v_mfma_f32_16x16x32_bf16 v[64:67], v[32:35], v[192:195], 0
ds_read_b64_tr_b16 v[48:49], v174 offset:4608
s_add_u32 m0, s66, 40960
s_add_u32 s59, s67, 1310720
buffer_load_dwordx4 v173, s[4:7], s59 offen lds
v_mfma_f32_16x16x32_bf16 v[80:83], v[32:35], v[196:199], 0
ds_read_b64_tr_b16 v[50:51], v174 offset:4864
v_mfma_f32_16x16x32_bf16 v[68:71], v[36:39], v[192:195], 0
ds_read_b64_tr_b16 v[52:53], v175 offset:4608
v_mfma_f32_16x16x32_bf16 v[84:87], v[36:39], v[196:199], 0
ds_read_b64_tr_b16 v[54:55], v175 offset:4864
s_waitcnt vmcnt(29) lgkmcnt(0)
v_mfma_f32_16x16x32_bf16 v[56:59], v[40:43], v[200:203], v[56:59]
ds_read_b64_tr_b16 v[24:25], v174 offset:8192
v_mfma_f32_16x16x32_bf16 v[72:75], v[40:43], v[204:207], v[72:75]
ds_read_b64_tr_b16 v[26:27], v174 offset:8448
buffer_load_dwordx4 v[112:115], v172, s[12:15], s68 offen sc1
buffer_load_dwordx4 v[116:119], v172, s[12:15], s68 offen offset:256 sc1
s_add_u32 s68, s68, 16384
v_mfma_f32_16x16x32_bf16 v[60:63], v[44:47], v[200:203], v[60:63]
ds_read_b64_tr_b16 v[28:29], v175 offset:8192
v_mfma_f32_16x16x32_bf16 v[76:79], v[44:47], v[204:207], v[76:79]
ds_read_b64_tr_b16 v[30:31], v175 offset:8448
v_mfma_f32_16x16x32_bf16 v[64:67], v[48:51], v[200:203], v[64:67]
ds_read_b64_tr_b16 v[32:33], v174 offset:8704
s_add_u32 m0, s66, 45056
s_add_u32 s59, s67, 1441792
buffer_load_dwordx4 v173, s[4:7], s59 offen lds
v_mfma_f32_16x16x32_bf16 v[80:83], v[48:51], v[204:207], v[80:83]
ds_read_b64_tr_b16 v[34:35], v174 offset:8960
v_mfma_f32_16x16x32_bf16 v[68:71], v[52:55], v[200:203], v[68:71]
ds_read_b64_tr_b16 v[36:37], v175 offset:8704
v_mfma_f32_16x16x32_bf16 v[84:87], v[52:55], v[204:207], v[84:87]
ds_read_b64_tr_b16 v[38:39], v175 offset:8960
s_waitcnt vmcnt(29) lgkmcnt(0)
v_mfma_f32_16x16x32_bf16 v[56:59], v[24:27], v[208:211], v[56:59]
ds_read_b64_tr_b16 v[40:41], v174 offset:12288
v_mfma_f32_16x16x32_bf16 v[72:75], v[24:27], v[212:215], v[72:75]
ds_read_b64_tr_b16 v[42:43], v174 offset:12544
buffer_load_dwordx4 v[144:147], v172, s[12:15], s68 offen sc1
buffer_load_dwordx4 v[148:151], v172, s[12:15], s68 offen offset:256 sc1
s_add_u32 s68, s68, 16384
v_mfma_f32_16x16x32_bf16 v[60:63], v[28:31], v[208:211], v[60:63]
ds_read_b64_tr_b16 v[44:45], v175 offset:12288
v_mfma_f32_16x16x32_bf16 v[76:79], v[28:31], v[212:215], v[76:79]
ds_read_b64_tr_b16 v[46:47], v175 offset:12544
v_mfma_f32_16x16x32_bf16 v[64:67], v[32:35], v[208:211], v[64:67]
ds_read_b64_tr_b16 v[48:49], v174 offset:12800
s_add_u32 m0, s66, 98304
s_add_u32 s59, s67, 1572864
buffer_load_dwordx4 v173, s[4:7], s59 offen lds
v_mfma_f32_16x16x32_bf16 v[80:83], v[32:35], v[212:215], v[80:83]
ds_read_b64_tr_b16 v[50:51], v174 offset:13056
v_mfma_f32_16x16x32_bf16 v[68:71], v[36:39], v[208:211], v[68:71]
ds_read_b64_tr_b16 v[52:53], v175 offset:12800
v_mfma_f32_16x16x32_bf16 v[84:87], v[36:39], v[212:215], v[84:87]
ds_read_b64_tr_b16 v[54:55], v175 offset:13056
s_waitcnt vmcnt(9) lgkmcnt(0)
s_barrier
v_mfma_f32_16x16x32_bf16 v[56:59], v[40:43], v[216:219], v[56:59]
ds_read_b64_tr_b16 v[24:25], v189 offset:0
s_cmp_eq_u32 s20, 0
s_cbranch_scc0 K3_nofl
s_add_u32 s34, s32, 1024
v_mov_b32 v4, 1
s_mov_b64 exec, 1
buffer_store_dword v4, off, s[12:15], s34 sc1
s_mov_b64 exec, -1
K3_nofl:
v_mfma_f32_16x16x32_bf16 v[72:75], v[40:43], v[220:223], v[72:75]
ds_read_b64_tr_b16 v[26:27], v189 offset:256
buffer_load_dwordx4 v[152:155], v172, s[12:15], s68 offen sc1
buffer_load_dwordx4 v[156:159], v172, s[12:15], s68 offen offset:256 sc1
s_add_u32 s68, s68, 16384
v_mfma_f32_16x16x32_bf16 v[60:63], v[44:47], v[216:219], v[60:63]
ds_read_b64_tr_b16 v[28:29], v191 offset:0
v_mfma_f32_16x16x32_bf16 v[76:79], v[44:47], v[220:223], v[76:79]
ds_read_b64_tr_b16 v[30:31], v191 offset:256
v_mfma_f32_16x16x32_bf16 v[64:67], v[48:51], v[216:219], v[64:67]
ds_read_b64_tr_b16 v[32:33], v189 offset:512
s_add_u32 m0, s66, 102400
s_add_u32 s59, s67, 1703936
buffer_load_dwordx4 v173, s[4:7], s59 offen lds
v_mfma_f32_16x16x32_bf16 v[80:83], v[48:51], v[220:223], v[80:83]
ds_read_b64_tr_b16 v[34:35], v189 offset:768
v_mfma_f32_16x16x32_bf16 v[68:71], v[52:55], v[216:219], v[68:71]
ds_read_b64_tr_b16 v[36:37], v191 offset:512
v_mfma_f32_16x16x32_bf16 v[84:87], v[52:55], v[220:223], v[84:87]
ds_read_b64_tr_b16 v[38:39], v191 offset:768
s_waitcnt vmcnt(29) lgkmcnt(0)
v_mfma_f32_16x16x32_bf16 v[56:59], v[24:27], v[224:227], v[56:59]
ds_read_b64_tr_b16 v[40:41], v189 offset:4096
v_mfma_f32_16x16x32_bf16 v[72:75], v[24:27], v[228:231], v[72:75]
ds_read_b64_tr_b16 v[42:43], v189 offset:4352
buffer_load_dwordx4 v[128:131], v172, s[12:15], s68 offen sc1
buffer_load_dwordx4 v[132:135], v172, s[12:15], s68 offen offset:256 sc1
s_add_u32 s68, s68, 16384
v_mfma_f32_16x16x32_bf16 v[60:63], v[28:31], v[224:227], v[60:63]
ds_read_b64_tr_b16 v[44:45], v191 offset:4096
v_mfma_f32_16x16x32_bf16 v[76:79], v[28:31], v[228:231], v[76:79]
ds_read_b64_tr_b16 v[46:47], v191 offset:4352
v_mfma_f32_16x16x32_bf16 v[64:67], v[32:35], v[224:227], v[64:67]
ds_read_b64_tr_b16 v[48:49], v189 offset:4608
s_add_u32 m0, s66, 106496
s_add_u32 s59, s67, 1835008
buffer_load_dwordx4 v173, s[4:7], s59 offen lds
v_mfma_f32_16x16x32_bf16 v[80:83], v[32:35], v[228:231], v[80:83]
ds_read_b64_tr_b16 v[50:51], v189 offset:4864
v_mfma_f32_16x16x32_bf16 v[68:71], v[36:39], v[224:227], v[68:71]
ds_read_b64_tr_b16 v[52:53], v191 offset:4608
v_mfma_f32_16x16x32_bf16 v[84:87], v[36:39], v[228:231], v[84:87]
ds_read_b64_tr_b16 v[54:55], v191 offset:4864
s_waitcnt vmcnt(29) lgkmcnt(0)
v_mfma_f32_16x16x32_bf16 v[56:59], v[40:43], v[232:235], v[56:59]
ds_read_b64_tr_b16 v[24:25], v189 offset:8192
v_mfma_f32_16x16x32_bf16 v[72:75], v[40:43], v[236:239], v[72:75]
ds_read_b64_tr_b16 v[26:27], v189 offset:8448
buffer_load_dwordx4 v[136:139], v172, s[12:15], s68 offen sc1
buffer_load_dwordx4 v[140:143], v172, s[12:15], s68 offen offset:256 sc1
s_add_u32 s68, s68, 16384
v_mfma_f32_16x16x32_bf16 v[60:63], v[44:47], v[232:235], v[60:63]
ds_read_b64_tr_b16 v[28:29], v191 offset:8192
v_mfma_f32_16x16x32_bf16 v[76:79], v[44:47], v[236:239], v[76:79]
ds_read_b64_tr_b16 v[30:31], v191 offset:8448
v_mfma_f32_16x16x32_bf16 v[64:67], v[48:51], v[232:235], v[64:67]
ds_read_b64_tr_b16 v[32:33], v189 offset:8704
s_add_u32 m0, s66, 110592
s_add_u32 s59, s67, 1966080
buffer_load_dwordx4 v173, s[4:7], s59 offen lds
v_mfma_f32_16x16x32_bf16 v[80:83], v[48:51], v[236:239], v[80:83]
ds_read_b64_tr_b16 v[34:35], v189 offset:8960
v_mfma_f32_16x16x32_bf16 v[68:71], v[52:55], v[232:235], v[68:71]
ds_read_b64_tr_b16 v[36:37], v191 offset:8704
v_mfma_f32_16x16x32_bf16 v[84:87], v[52:55], v[236:239], v[84:87]
ds_read_b64_tr_b16 v[38:39], v191 offset:8960
s_waitcnt vmcnt(29) lgkmcnt(0)
v_mfma_f32_16x16x32_bf16 v[56:59], v[24:27], v[240:243], v[56:59]
ds_read_b64_tr_b16 v[40:41], v189 offset:12288
v_mfma_f32_16x16x32_bf16 v[72:75], v[24:27], v[244:247], v[72:75]
ds_read_b64_tr_b16 v[42:43], v189 offset:12544
s_add_u32 m0, s66, 0
s_add_u32 s59, s67, 0
buffer_load_dwordx4 v173, s[8:11], s59 offen lds
v_mfma_f32_16x16x32_bf16 v[60:63], v[28:31], v[240:243], v[60:63]
ds_read_b64_tr_b16 v[44:45], v191 offset:12288
v_mfma_f32_16x16x32_bf16 v[76:79], v[28:31], v[244:247], v[76:79]
ds_read_b64_tr_b16 v[46:47], v191 offset:12544
v_mfma_f32_16x16x32_bf16 v[64:67], v[32:35], v[240:243], v[64:67]
ds_read_b64_tr_b16 v[48:49], v189 offset:12800
v_mfma_f32_16x16x32_bf16 v[80:83], v[32:35], v[244:247], v[80:83]
ds_read_b64_tr_b16 v[50:51], v189 offset:13056
v_mfma_f32_16x16x32_bf16 v[68:71], v[36:39], v[240:243], v[68:71]
ds_read_b64_tr_b16 v[52:53], v191 offset:12800
v_mfma_f32_16x16x32_bf16 v[84:87], v[36:39], v[244:247], v[84:87]
ds_read_b64_tr_b16 v[54:55], v191 offset:13056
s_waitcnt vmcnt(13) lgkmcnt(0)
s_barrier
v_mfma_f32_16x16x32_bf16 v[56:59], v[40:43], v[248:251], v[56:59]
ds_read_b64_tr_b16 v[24:25], v174 offset:32768
v_mfma_f32_16x16x32_bf16 v[72:75], v[40:43], v[252:255], v[72:75]
ds_read_b64_tr_b16 v[26:27], v174 offset:33024
s_add_u32 m0, s66, 4096
s_add_u32 s59, s67, 131072
buffer_load_dwordx4 v173, s[8:11], s59 offen lds
v_mfma_f32_16x16x32_bf16 v[60:63], v[44:47], v[248:251], v[60:63]
ds_read_b64_tr_b16 v[28:29], v175 offset:32768
v_mfma_f32_16x16x32_bf16 v[76:79], v[44:47], v[252:255], v[76:79]
ds_read_b64_tr_b16 v[30:31], v175 offset:33024
v_mfma_f32_16x16x32_bf16 v[64:67], v[48:51], v[248:251], v[64:67]
ds_read_b64_tr_b16 v[32:33], v174 offset:33280
v_mfma_f32_16x16x32_bf16 v[80:83], v[48:51], v[252:255], v[80:83]
ds_read_b64_tr_b16 v[34:35], v174 offset:33536
v_mfma_f32_16x16x32_bf16 v[68:71], v[52:55], v[248:251], v[68:71]
ds_read_b64_tr_b16 v[36:37], v175 offset:33280
v_mfma_f32_16x16x32_bf16 v[84:87], v[52:55], v[252:255], v[84:87]
ds_read_b64_tr_b16 v[38:39], v175 offset:33536
s_waitcnt vmcnt(26) lgkmcnt(0)
v_mfma_f32_16x16x32_bf16 v[56:59], v[24:27], v[88:91], v[56:59]
ds_read_b64_tr_b16 v[40:41], v174 offset:36864
v_mfma_f32_16x16x32_bf16 v[72:75], v[24:27], v[92:95], v[72:75]
ds_read_b64_tr_b16 v[42:43], v174 offset:37120
s_add_u32 m0, s66, 8192
s_add_u32 s59, s67, 262144
buffer_load_dwordx4 v173, s[8:11], s59 offen lds
v_mfma_f32_16x16x32_bf16 v[60:63], v[28:31], v[88:91], v[60:63]
ds_read_b64_tr_b16 v[44:45], v175 offset:36864
v_mfma_f32_16x16x32_bf16 v[76:79], v[28:31], v[92:95], v[76:79]
ds_read_b64_tr_b16 v[46:47], v175 offset:37120
v_mfma_f32_16x16x32_bf16 v[64:67], v[32:35], v[88:91], v[64:67]
ds_read_b64_tr_b16 v[48:49], v174 offset:37376
v_mfma_f32_16x16x32_bf16 v[80:83], v[32:35], v[92:95], v[80:83]
ds_read_b64_tr_b16 v[50:51], v174 offset:37632
v_mfma_f32_16x16x32_bf16 v[68:71], v[36:39], v[88:91], v[68:71]
ds_read_b64_tr_b16 v[52:53], v175 offset:37376
v_mfma_f32_16x16x32_bf16 v[84:87], v[36:39], v[92:95], v[84:87]
ds_read_b64_tr_b16 v[54:55], v175 offset:37632
s_waitcnt vmcnt(25) lgkmcnt(0)
v_mfma_f32_16x16x32_bf16 v[56:59], v[40:43], v[96:99], v[56:59]
ds_read_b64_tr_b16 v[24:25], v174 offset:40960
v_mfma_f32_16x16x32_bf16 v[72:75], v[40:43], v[100:103], v[72:75]
ds_read_b64_tr_b16 v[26:27], v174 offset:41216
s_add_u32 m0, s66, 12288
s_add_u32 s59, s67, 393216
buffer_load_dwordx4 v173, s[8:11], s59 offen lds
v_mfma_f32_16x16x32_bf16 v[60:63], v[44:47], v[96:99], v[60:63]
ds_read_b64_tr_b16 v[28:29], v175 offset:40960
v_mfma_f32_16x16x32_bf16 v[76:79], v[44:47], v[100:103], v[76:79]
ds_read_b64_tr_b16 v[30:31], v175 offset:41216
v_mfma_f32_16x16x32_bf16 v[64:67], v[48:51], v[96:99], v[64:67]
ds_read_b64_tr_b16 v[32:33], v174 offset:41472
v_mfma_f32_16x16x32_bf16 v[80:83], v[48:51], v[100:103], v[80:83]
ds_read_b64_tr_b16 v[34:35], v174 offset:41728
v_mfma_f32_16x16x32_bf16 v[68:71], v[52:55], v[96:99], v[68:71]
ds_read_b64_tr_b16 v[36:37], v175 offset:41472
v_mfma_f32_16x16x32_bf16 v[84:87], v[52:55], v[100:103], v[84:87]
ds_read_b64_tr_b16 v[38:39], v175 offset:41728
s_add_u32 s34, s33, 1024
buffer_load_dword v178, v179, s[12:15], s34 offen sc1
s_waitcnt vmcnt(21) lgkmcnt(0)
v_mfma_f32_16x16x32_bf16 v[56:59], v[24:27], v[104:107], v[56:59]
ds_read_b64_tr_b16 v[40:41], v174 offset:45056
v_mfma_f32_16x16x32_bf16 v[72:75], v[24:27], v[108:111], v[72:75]
ds_read_b64_tr_b16 v[42:43], v174 offset:45312
s_add_u32 m0, s66, 65536
s_add_u32 s59, s67, 524288
buffer_load_dwordx4 v173, s[8:11], s59 offen lds
v_mfma_f32_16x16x32_bf16 v[60:63], v[28:31], v[104:107], v[60:63]
ds_read_b64_tr_b16 v[44:45], v175 offset:45056
v_mfma_f32_16x16x32_bf16 v[76:79], v[28:31], v[108:111], v[76:79]
ds_read_b64_tr_b16 v[46:47], v175 offset:45312
v_mfma_f32_16x16x32_bf16 v[64:67], v[32:35], v[104:107], v[64:67]
ds_read_b64_tr_b16 v[48:49], v174 offset:45568
v_mfma_f32_16x16x32_bf16 v[80:83], v[32:35], v[108:111], v[80:83]
ds_read_b64_tr_b16 v[50:51], v174 offset:45824
v_mfma_f32_16x16x32_bf16 v[68:71], v[36:39], v[104:107], v[68:71]
ds_read_b64_tr_b16 v[52:53], v175 offset:45568
v_mfma_f32_16x16x32_bf16 v[84:87], v[36:39], v[108:111], v[84:87]
ds_read_b64_tr_b16 v[54:55], v175 offset:45824
s_waitcnt vmcnt(6) lgkmcnt(0)
s_barrier
v_mfma_f32_16x16x32_bf16 v[56:59], v[40:43], v[112:115], v[56:59]
ds_read_b64_tr_b16 v[24:25], v189 offset:32768
v_mfma_f32_16x16x32_bf16 v[72:75], v[40:43], v[116:119], v[72:75]
ds_read_b64_tr_b16 v[26:27], v189 offset:33024
s_add_u32 m0, s66, 69632
s_add_u32 s59, s67, 655360
buffer_load_dwordx4 v173, s[8:11], s59 offen lds
v_mfma_f32_16x16x32_bf16 v[60:63], v[44:47], v[112:115], v[60:63]
ds_read_b64_tr_b16 v[28:29], v191 offset:32768
v_mfma_f32_16x16x32_bf16 v[76:79], v[44:47], v[116:119], v[76:79]
ds_read_b64_tr_b16 v[30:31], v191 offset:33024
v_mfma_f32_16x16x32_bf16 v[64:67], v[48:51], v[112:115], v[64:67]
ds_read_b64_tr_b16 v[32:33], v189 offset:33280
v_mfma_f32_16x16x32_bf16 v[80:83], v[48:51], v[116:119], v[80:83]
ds_read_b64_tr_b16 v[34:35], v189 offset:33536
v_mfma_f32_16x16x32_bf16 v[68:71], v[52:55], v[112:115], v[68:71]
ds_read_b64_tr_b16 v[36:37], v191 offset:33280
v_mfma_f32_16x16x32_bf16 v[84:87], v[52:55], v[116:119], v[84:87]
ds_read_b64_tr_b16 v[38:39], v191 offset:33536
s_waitcnt vmcnt(2) lgkmcnt(0)
v_cmp_ne_u32 vcc, 1, v178
v_mfma_f32_16x16x32_bf16 v[56:59], v[24:27], v[144:147], v[56:59]
ds_read_b64_tr_b16 v[40:41], v189 offset:36864
s_cbranch_vccnz K3_spinB
K3_spinB_b:
v_mfma_f32_16x16x32_bf16 v[72:75], v[24:27], v[148:151], v[72:75]
ds_read_b64_tr_b16 v[42:43], v189 offset:37120
buffer_load_dwordx4 v[192:195], v172, s[12:15], s68 offen sc1
buffer_load_dwordx4 v[196:199], v172, s[12:15], s68 offen offset:256 sc1
s_add_u32 s68, s68, 16384
v_mfma_f32_16x16x32_bf16 v[60:63], v[28:31], v[144:147], v[60:63]
ds_read_b64_tr_b16 v[44:45], v191 offset:36864
v_mfma_f32_16x16x32_bf16 v[76:79], v[28:31], v[148:151], v[76:79]
ds_read_b64_tr_b16 v[46:47], v191 offset:37120
v_mfma_f32_16x16x32_bf16 v[64:67], v[32:35], v[144:147], v[64:67]
ds_read_b64_tr_b16 v[48:49], v189 offset:37376
buffer_load_dwordx4 v[200:203], v172, s[12:15], s68 offen sc1
buffer_load_dwordx4 v[204:207], v172, s[12:15], s68 offen offset:256 sc1
s_add_u32 s68, s68, 16384
v_mfma_f32_16x16x32_bf16 v[80:83], v[32:35], v[148:151], v[80:83]
ds_read_b64_tr_b16 v[50:51], v189 offset:37632
v_mfma_f32_16x16x32_bf16 v[68:71], v[36:39], v[144:147], v[68:71]
ds_read_b64_tr_b16 v[52:53], v191 offset:37376
v_mfma_f32_16x16x32_bf16 v[84:87], v[36:39], v[148:151], v[84:87]
ds_read_b64_tr_b16 v[54:55], v191 offset:37632
s_waitcnt vmcnt(18) lgkmcnt(0)
v_mfma_f32_16x16x32_bf16 v[56:59], v[40:43], v[152:155], v[56:59]
ds_read_b64_tr_b16 v[24:25], v189 offset:40960
v_mfma_f32_16x16x32_bf16 v[72:75], v[40:43], v[156:159], v[72:75]
ds_read_b64_tr_b16 v[26:27], v189 offset:41216
buffer_load_dwordx4 v[208:211], v172, s[12:15], s68 offen sc1
buffer_load_dwordx4 v[212:215], v172, s[12:15], s68 offen offset:256 sc1
s_add_u32 s68, s68, 16384
v_mfma_f32_16x16x32_bf16 v[60:63], v[44:47], v[152:155], v[60:63]
ds_read_b64_tr_b16 v[28:29], v191 offset:40960
v_mfma_f32_16x16x32_bf16 v[76:79], v[44:47], v[156:159], v[76:79]
ds_read_b64_tr_b16 v[30:31], v191 offset:41216
v_mfma_f32_16x16x32_bf16 v[64:67], v[48:51], v[152:155], v[64:67]
ds_read_b64_tr_b16 v[32:33], v189 offset:41472
buffer_load_dwordx4 v[216:219], v172, s[12:15], s68 offen sc1
buffer_load_dwordx4 v[220:223], v172, s[12:15], s68 offen offset:256 sc1
s_add_u32 s68, s68, 16384
v_mfma_f32_16x16x32_bf16 v[80:83], v[48:51], v[156:159], v[80:83]
ds_read_b64_tr_b16 v[34:35], v189 offset:41728
v_mfma_f32_16x16x32_bf16 v[68:71], v[52:55], v[152:155], v[68:71]
ds_read_b64_tr_b16 v[36:37], v191 offset:41472
v_mfma_f32_16x16x32_bf16 v[84:87], v[52:55], v[156:159], v[84:87]
ds_read_b64_tr_b16 v[38:39], v191 offset:41728
s_waitcnt vmcnt(19) lgkmcnt(0)
v_mfma_f32_16x16x32_bf16 v[56:59], v[24:27], v[128:131], v[56:59]
ds_read_b64_tr_b16 v[40:41], v189 offset:45056
v_mfma_f32_16x16x32_bf16 v[72:75], v[24:27], v[132:135], v[72:75]
ds_read_b64_tr_b16 v[42:43], v189 offset:45312
buffer_load_dwordx4 v[224:227], v172, s[12:15], s68 offen sc1
buffer_load_dwordx4 v[228:231], v172, s[12:15], s68 offen offset:256 sc1
s_add_u32 s68, s68, 16384
v_mfma_f32_16x16x32_bf16 v[60:63], v[28:31], v[128:131], v[60:63]
ds_read_b64_tr_b16 v[44:45], v191 offset:45056
v_mfma_f32_16x16x32_bf16 v[76:79], v[28:31], v[132:135], v[76:79]
ds_read_b64_tr_b16 v[46:47], v191 offset:45312
v_mfma_f32_16x16x32_bf16 v[64:67], v[32:35], v[128:131], v[64:67]
ds_read_b64_tr_b16 v[48:49], v189 offset:45568
s_add_u32 m0, s66, 73728
s_add_u32 s59, s67, 786432
buffer_load_dwordx4 v173, s[8:11], s59 offen lds
v_mfma_f32_16x16x32_bf16 v[80:83], v[32:35], v[132:135], v[80:83]
ds_read_b64_tr_b16 v[50:51], v189 offset:45824
v_mfma_f32_16x16x32_bf16 v[68:71], v[36:39], v[128:131], v[68:71]
ds_read_b64_tr_b16 v[52:53], v191 offset:45568
v_mfma_f32_16x16x32_bf16 v[84:87], v[36:39], v[132:135], v[84:87]
ds_read_b64_tr_b16 v[54:55], v191 offset:45824
s_waitcnt vmcnt(14) lgkmcnt(0)
s_barrier
v_mfma_f32_16x16x32_bf16 v[56:59], v[40:43], v[136:139], v[56:59]
ds_read_b64_tr_b16 v[24:25], v174 offset:0
v_mfma_f32_16x16x32_bf16 v[72:75], v[40:43], v[140:143], v[72:75]
ds_read_b64_tr_b16 v[26:27], v174 offset:256
buffer_load_dwordx4 v[232:235], v172, s[12:15], s68 offen sc1
buffer_load_dwordx4 v[236:239], v172, s[12:15], s68 offen offset:256 sc1
s_add_u32 s68, s68, 16384
v_mfma_f32_16x16x32_bf16 v[60:63], v[44:47], v[136:139], v[60:63]
ds_read_b64_tr_b16 v[28:29], v175 offset:0
v_mfma_f32_16x16x32_bf16 v[76:79], v[44:47], v[140:143], v[76:79]
ds_read_b64_tr_b16 v[30:31], v175 offset:256
v_mfma_f32_16x16x32_bf16 v[64:67], v[48:51], v[136:139], v[64:67]
ds_read_b64_tr_b16 v[32:33], v174 offset:512
s_add_u32 m0, s66, 77824
s_add_u32 s59, s67, 917504
buffer_load_dwordx4 v173, s[8:11], s59 offen lds
v_mfma_f32_16x16x32_bf16 v[80:83], v[48:51], v[140:143], v[80:83]
ds_read_b64_tr_b16 v[34:35], v174 offset:768
v_mfma_f32_16x16x32_bf16 v[68:71], v[52:55], v[136:139], v[68:71]
ds_read_b64_tr_b16 v[36:37], v175 offset:512
v_mfma_f32_16x16x32_bf16 v[84:87], v[52:55], v[140:143], v[84:87]
ds_read_b64_tr_b16 v[38:39], v175 offset:768
s_waitcnt vmcnt(12) lgkmcnt(0)
v_mfma_f32_16x16x32_bf16 v[56:59], v[24:27], v[192:195], v[56:59]
ds_read_b64_tr_b16 v[40:41], v174 offset:4096
v_mfma_f32_16x16x32_bf16 v[72:75], v[24:27], v[196:199], v[72:75]
ds_read_b64_tr_b16 v[42:43], v174 offset:4352
buffer_load_dwordx4 v[240:243], v172, s[12:15], s68 offen sc1
buffer_load_dwordx4 v[244:247], v172, s[12:15], s68 offen offset:256 sc1
s_add_u32 s68, s68, 16384
v_mfma_f32_16x16x32_bf16 v[60:63], v[28:31], v[192:195], v[60:63]
ds_read_b64_tr_b16 v[44:45], v175 offset:4096
v_mfma_f32_16x16x32_bf16 v[76:79], v[28:31], v[196:199], v[76:79]
ds_read_b64_tr_b16 v[46:47], v175 offset:4352
v_mfma_f32_16x16x32_bf16 v[64:67], v[32:35], v[192:195], v[64:67]
ds_read_b64_tr_b16 v[48:49], v174 offset:4608
s_add_u32 m0, s66, 32768
s_add_u32 s59, s67, 1048576
buffer_load_dwordx4 v173, s[8:11], s59 offen lds
v_mfma_f32_16x16x32_bf16 v[80:83], v[32:35], v[196:199], v[80:83]
ds_read_b64_tr_b16 v[50:51], v174 offset:4864
v_mfma_f32_16x16x32_bf16 v[68:71], v[36:39], v[192:195], v[68:71]
ds_read_b64_tr_b16 v[52:53], v175 offset:4608
v_mfma_f32_16x16x32_bf16 v[84:87], v[36:39], v[196:199], v[84:87]
ds_read_b64_tr_b16 v[54:55], v175 offset:4864
s_waitcnt vmcnt(13) lgkmcnt(0)
v_mfma_f32_16x16x32_bf16 v[56:59], v[40:43], v[200:203], v[56:59]
ds_read_b64_tr_b16 v[24:25], v174 offset:8192
v_mfma_f32_16x16x32_bf16 v[72:75], v[40:43], v[204:207], v[72:75]
ds_read_b64_tr_b16 v[26:27], v174 offset:8448
buffer_load_dwordx4 v[248:251], v172, s[12:15], s68 offen sc1
buffer_load_dwordx4 v[252:255], v172, s[12:15], s68 offen offset:256 sc1
s_add_u32 s68, s68, 16384
v_mfma_f32_16x16x32_bf16 v[60:63], v[44:47], v[200:203], v[60:63]
ds_read_b64_tr_b16 v[28:29], v175 offset:8192
v_mfma_f32_16x16x32_bf16 v[76:79], v[44:47], v[204:207], v[76:79]
ds_read_b64_tr_b16 v[30:31], v175 offset:8448
v_mfma_f32_16x16x32_bf16 v[64:67], v[48:51], v[200:203], v[64:67]
ds_read_b64_tr_b16 v[32:33], v174 offset:8704
s_add_u32 m0, s66, 36864
s_add_u32 s59, s67, 1179648
buffer_load_dwordx4 v173, s[8:11], s59 offen lds
v_mfma_f32_16x16x32_bf16 v[80:83], v[48:51], v[204:207], v[80:83]
ds_read_b64_tr_b16 v[34:35], v174 offset:8960
v_mfma_f32_16x16x32_bf16 v[68:71], v[52:55], v[200:203], v[68:71]
ds_read_b64_tr_b16 v[36:37], v175 offset:8704
v_mfma_f32_16x16x32_bf16 v[84:87], v[52:55], v[204:207], v[84:87]
ds_read_b64_tr_b16 v[38:39], v175 offset:8960
s_waitcnt vmcnt(14) lgkmcnt(0)
v_mfma_f32_16x16x32_bf16 v[56:59], v[24:27], v[208:211], v[56:59]
ds_read_b64_tr_b16 v[40:41], v174 offset:12288
v_mfma_f32_16x16x32_bf16 v[72:75], v[24:27], v[212:215], v[72:75]
ds_read_b64_tr_b16 v[42:43], v174 offset:12544
buffer_load_dwordx4 v[88:91], v172, s[12:15], s68 offen sc1
buffer_load_dwordx4 v[92:95], v172, s[12:15], s68 offen offset:256 sc1
s_add_u32 s68, s68, 16384
v_mfma_f32_16x16x32_bf16 v[60:63], v[28:31], v[208:211], v[60:63]
ds_read_b64_tr_b16 v[44:45], v175 offset:12288
v_mfma_f32_16x16x32_bf16 v[76:79], v[28:31], v[212:215], v[76:79]
ds_read_b64_tr_b16 v[46:47], v175 offset:12544
v_mfma_f32_16x16x32_bf16 v[64:67], v[32:35], v[208:211], v[64:67]
ds_read_b64_tr_b16 v[48:49], v174 offset:12800
s_add_u32 m0, s66, 40960
s_add_u32 s59, s67, 1310720
buffer_load_dwordx4 v173, s[8:11], s59 offen lds
v_mfma_f32_16x16x32_bf16 v[80:83], v[32:35], v[212:215], v[80:83]
ds_read_b64_tr_b16 v[50:51], v174 offset:13056
v_mfma_f32_16x16x32_bf16 v[68:71], v[36:39], v[208:211], v[68:71]
ds_read_b64_tr_b16 v[52:53], v175 offset:12800
v_mfma_f32_16x16x32_bf16 v[84:87], v[36:39], v[212:215], v[84:87]
ds_read_b64_tr_b16 v[54:55], v175 offset:13056
s_waitcnt vmcnt(9) lgkmcnt(0)
s_barrier
v_mfma_f32_16x16x32_bf16 v[56:59], v[40:43], v[216:219], v[56:59]
ds_read_b64_tr_b16 v[24:25], v189 offset:0
v_mfma_f32_16x16x32_bf16 v[72:75], v[40:43], v[220:223], v[72:75]
ds_read_b64_tr_b16 v[26:27], v189 offset:256
buffer_load_dwordx4 v[96:99], v172, s[12:15], s68 offen sc1
buffer_load_dwordx4 v[100:103], v172, s[12:15], s68 offen offset:256 sc1
s_add_u32 s68, s68, 16384
v_mfma_f32_16x16x32_bf16 v[60:63], v[44:47], v[216:219], v[60:63]
ds_read_b64_tr_b16 v[28:29], v191 offset:0
v_mfma_f32_16x16x32_bf16 v[76:79], v[44:47], v[220:223], v[76:79]
ds_read_b64_tr_b16 v[30:31], v191 offset:256
v_mfma_f32_16x16x32_bf16 v[64:67], v[48:51], v[216:219], v[64:67]
ds_read_b64_tr_b16 v[32:33], v189 offset:512
s_add_u32 m0, s66, 45056
s_add_u32 s59, s67, 1441792
buffer_load_dwordx4 v173, s[8:11], s59 offen lds
v_mfma_f32_16x16x32_bf16 v[80:83], v[48:51], v[220:223], v[80:83]
ds_read_b64_tr_b16 v[34:35], v189 offset:768
v_mfma_f32_16x16x32_bf16 v[68:71], v[52:55], v[216:219], v[68:71]
ds_read_b64_tr_b16 v[36:37], v191 offset:512
v_mfma_f32_16x16x32_bf16 v[84:87], v[52:55], v[220:223], v[84:87]
ds_read_b64_tr_b16 v[38:39], v191 offset:768
s_waitcnt vmcnt(16) lgkmcnt(0)
v_mfma_f32_16x16x32_bf16 v[56:59], v[24:27], v[224:227], v[56:59]
ds_read_b64_tr_b16 v[40:41], v189 offset:4096
v_mfma_f32_16x16x32_bf16 v[72:75], v[24:27], v[228:231], v[72:75]
ds_read_b64_tr_b16 v[42:43], v189 offset:4352
buffer_load_dwordx4 v[104:107], v172, s[12:15], s68 offen sc1
buffer_load_dwordx4 v[108:111], v172, s[12:15], s68 offen offset:256 sc1
s_add_u32 s68, s68, 16384
v_mfma_f32_16x16x32_bf16 v[60:63], v[28:31], v[224:227], v[60:63]
ds_read_b64_tr_b16 v[44:45], v191 offset:4096
v_mfma_f32_16x16x32_bf16 v[76:79], v[28:31], v[228:231], v[76:79]
ds_read_b64_tr_b16 v[46:47], v191 offset:4352
v_mfma_f32_16x16x32_bf16 v[64:67], v[32:35], v[224:227], v[64:67]
ds_read_b64_tr_b16 v[48:49], v189 offset:4608
s_add_u32 m0, s66, 131072
s_add_u32 s59, s67, 1572864
buffer_load_dwordx4 v173, s[8:11], s59 offen lds
v_mfma_f32_16x16x32_bf16 v[80:83], v[32:35], v[228:231], v[80:83]
ds_read_b64_tr_b16 v[50:51], v189 offset:4864
v_mfma_f32_16x16x32_bf16 v[68:71], v[36:39], v[224:227], v[68:71]
ds_read_b64_tr_b16 v[52:53], v191 offset:4608
v_mfma_f32_16x16x32_bf16 v[84:87], v[36:39], v[228:231], v[84:87]
ds_read_b64_tr_b16 v[54:55], v191 offset:4864
s_waitcnt vmcnt(16) lgkmcnt(0)
v_mfma_f32_16x16x32_bf16 v[56:59], v[40:43], v[232:235], v[56:59]
ds_read_b64_tr_b16 v[24:25], v189 offset:8192
v_mfma_f32_16x16x32_bf16 v[72:75], v[40:43], v[236:239], v[72:75]
ds_read_b64_tr_b16 v[26:27], v189 offset:8448
buffer_load_dwordx4 v[112:115], v172, s[12:15], s68 offen sc1
buffer_load_dwordx4 v[116:119], v172, s[12:15], s68 offen offset:256 sc1
s_add_u32 s68, s68, 16384
v_mfma_f32_16x16x32_bf16 v[60:63], v[44:47], v[232:235], v[60:63]
ds_read_b64_tr_b16 v[28:29], v191 offset:8192
v_mfma_f32_16x16x32_bf16 v[76:79], v[44:47], v[236:239], v[76:79]
ds_read_b64_tr_b16 v[30:31], v191 offset:8448
v_mfma_f32_16x16x32_bf16 v[64:67], v[48:51], v[232:235], v[64:67]
ds_read_b64_tr_b16 v[32:33], v189 offset:8704
s_add_u32 m0, s66, 135168
s_add_u32 s59, s67, 1703936
buffer_load_dwordx4 v173, s[8:11], s59 offen lds
v_mfma_f32_16x16x32_bf16 v[80:83], v[48:51], v[236:239], v[80:83]
ds_read_b64_tr_b16 v[34:35], v189 offset:8960
v_mfma_f32_16x16x32_bf16 v[68:71], v[52:55], v[232:235], v[68:71]
ds_read_b64_tr_b16 v[36:37], v191 offset:8704
v_mfma_f32_16x16x32_bf16 v[84:87], v[52:55], v[236:239], v[84:87]
ds_read_b64_tr_b16 v[38:39], v191 offset:8960
s_waitcnt vmcnt(16) lgkmcnt(0)
v_mfma_f32_16x16x32_bf16 v[56:59], v[24:27], v[240:243], v[56:59]
ds_read_b64_tr_b16 v[40:41], v189 offset:12288
v_mfma_f32_16x16x32_bf16 v[72:75], v[24:27], v[244:247], v[72:75]
ds_read_b64_tr_b16 v[42:43], v189 offset:12544
buffer_load_dwordx4 v[144:147], v172, s[12:15], s68 offen sc1
buffer_load_dwordx4 v[148:151], v172, s[12:15], s68 offen offset:256 sc1
s_add_u32 s68, s68, 16384
v_mfma_f32_16x16x32_bf16 v[60:63], v[28:31], v[240:243], v[60:63]
ds_read_b64_tr_b16 v[44:45], v191 offset:12288
v_mfma_f32_16x16x32_bf16 v[76:79], v[28:31], v[244:247], v[76:79]
ds_read_b64_tr_b16 v[46:47], v191 offset:12544
v_mfma_f32_16x16x32_bf16 v[64:67], v[32:35], v[240:243], v[64:67]
ds_read_b64_tr_b16 v[48:49], v189 offset:12800
s_add_u32 m0, s66, 139264
s_add_u32 s59, s67, 1835008
buffer_load_dwordx4 v173, s[8:11], s59 offen lds
v_mfma_f32_16x16x32_bf16 v[80:83], v[32:35], v[244:247], v[80:83]
ds_read_b64_tr_b16 v[50:51], v189 offset:13056
v_mfma_f32_16x16x32_bf16 v[68:71], v[36:39], v[240:243], v[68:71]
ds_read_b64_tr_b16 v[52:53], v191 offset:12800
v_mfma_f32_16x16x32_bf16 v[84:87], v[36:39], v[244:247], v[84:87]
ds_read_b64_tr_b16 v[54:55], v191 offset:13056
s_waitcnt vmcnt(9) lgkmcnt(0)
s_barrier
v_mfma_f32_16x16x32_bf16 v[56:59], v[40:43], v[248:251], v[56:59]
ds_read_b64_tr_b16 v[24:25], v174 offset:32768
v_mfma_f32_16x16x32_bf16 v[72:75], v[40:43], v[252:255], v[72:75]
ds_read_b64_tr_b16 v[26:27], v174 offset:33024
buffer_load_dwordx4 v[152:155], v172, s[12:15], s68 offen sc1
buffer_load_dwordx4 v[156:159], v172, s[12:15], s68 offen offset:256 sc1
s_add_u32 s68, s68, 16384
v_mfma_f32_16x16x32_bf16 v[60:63], v[44:47], v[248:251], v[60:63]
ds_read_b64_tr_b16 v[28:29], v175 offset:32768
v_mfma_f32_16x16x32_bf16 v[76:79], v[44:47], v[252:255], v[76:79]
ds_read_b64_tr_b16 v[30:31], v175 offset:33024
v_mfma_f32_16x16x32_bf16 v[64:67], v[48:51], v[248:251], v[64:67]
ds_read_b64_tr_b16 v[32:33], v174 offset:33280
s_add_u32 m0, s66, 143360
s_add_u32 s59, s67, 1966080
buffer_load_dwordx4 v173, s[8:11], s59 offen lds
v_mfma_f32_16x16x32_bf16 v[80:83], v[48:51], v[252:255], v[80:83]
ds_read_b64_tr_b16 v[34:35], v174 offset:33536
v_mfma_f32_16x16x32_bf16 v[68:71], v[52:55], v[248:251], v[68:71]
ds_read_b64_tr_b16 v[36:37], v175 offset:33280
v_mfma_f32_16x16x32_bf16 v[84:87], v[52:55], v[252:255], v[84:87]
ds_read_b64_tr_b16 v[38:39], v175 offset:33536
s_waitcnt vmcnt(16) lgkmcnt(0)
v_mfma_f32_16x16x32_bf16 v[56:59], v[24:27], v[88:91], v[56:59]
ds_read_b64_tr_b16 v[40:41], v174 offset:36864
v_add_u32 v189, 0x10000, v189
v_add_u32 v191, 0x10000, v191
v_mfma_f32_16x16x32_bf16 v[72:75], v[24:27], v[92:95], v[72:75]
ds_read_b64_tr_b16 v[42:43], v174 offset:37120
buffer_load_dwordx4 v[128:131], v172, s[12:15], s68 offen sc1
buffer_load_dwordx4 v[132:135], v172, s[12:15], s68 offen offset:256 sc1
s_add_u32 s68, s68, 16384
v_mfma_f32_16x16x32_bf16 v[60:63], v[28:31], v[88:91], v[60:63]
ds_read_b64_tr_b16 v[44:45], v175 offset:36864
v_mfma_f32_16x16x32_bf16 v[76:79], v[28:31], v[92:95], v[76:79]
ds_read_b64_tr_b16 v[46:47], v175 offset:37120
v_mfma_f32_16x16x32_bf16 v[64:67], v[32:35], v[88:91], v[64:67]
ds_read_b64_tr_b16 v[48:49], v174 offset:37376
v_mfma_f32_16x16x32_bf16 v[80:83], v[32:35], v[92:95], v[80:83]
ds_read_b64_tr_b16 v[50:51], v174 offset:37632
v_mfma_f32_16x16x32_bf16 v[68:71], v[36:39], v[88:91], v[68:71]
ds_read_b64_tr_b16 v[52:53], v175 offset:37376
v_mfma_f32_16x16x32_bf16 v[84:87], v[36:39], v[92:95], v[84:87]
ds_read_b64_tr_b16 v[54:55], v175 offset:37632
s_waitcnt vmcnt(15) lgkmcnt(0)
v_mfma_f32_16x16x32_bf16 v[56:59], v[40:43], v[96:99], v[56:59]
ds_read_b64_tr_b16 v[24:25], v174 offset:40960
v_mfma_f32_16x16x32_bf16 v[72:75], v[40:43], v[100:103], v[72:75]
ds_read_b64_tr_b16 v[26:27], v174 offset:41216
buffer_load_dwordx4 v[136:139], v172, s[12:15], s68 offen sc1
buffer_load_dwordx4 v[140:143], v172, s[12:15], s68 offen offset:256 sc1
s_add_u32 s68, s68, 16384
v_mfma_f32_16x16x32_bf16 v[60:63], v[44:47], v[96:99], v[60:63]
ds_read_b64_tr_b16 v[28:29], v175 offset:40960
v_mfma_f32_16x16x32_bf16 v[76:79], v[44:47], v[100:103], v[76:79]
ds_read_b64_tr_b16 v[30:31], v175 offset:41216
v_mfma_f32_16x16x32_bf16 v[64:67], v[48:51], v[96:99], v[64:67]
ds_read_b64_tr_b16 v[32:33], v174 offset:41472
v_mfma_f32_16x16x32_bf16 v[80:83], v[48:51], v[100:103], v[80:83]
ds_read_b64_tr_b16 v[34:35], v174 offset:41728
v_mfma_f32_16x16x32_bf16 v[68:71], v[52:55], v[96:99], v[68:71]
ds_read_b64_tr_b16 v[36:37], v175 offset:41472
v_mfma_f32_16x16x32_bf16 v[84:87], v[52:55], v[100:103], v[84:87]
ds_read_b64_tr_b16 v[38:39], v175 offset:41728
s_waitcnt vmcnt(14) lgkmcnt(0)
v_mfma_f32_16x16x32_bf16 v[56:59], v[24:27], v[104:107], v[56:59]
ds_read_b64_tr_b16 v[40:41], v174 offset:45056
v_mfma_f32_16x16x32_bf16 v[72:75], v[24:27], v[108:111], v[72:75]
ds_read_b64_tr_b16 v[42:43], v174 offset:45312
v_mfma_f32_16x16x32_bf16 v[60:63], v[28:31], v[104:107], v[60:63]
ds_read_b64_tr_b16 v[44:45], v175 offset:45056
v_mfma_f32_16x16x32_bf16 v[76:79], v[28:31], v[108:111], v[76:79]
ds_read_b64_tr_b16 v[46:47], v175 offset:45312
v_mfma_f32_16x16x32_bf16 v[64:67], v[32:35], v[104:107], v[64:67]
ds_read_b64_tr_b16 v[48:49], v174 offset:45568
v_mfma_f32_16x16x32_bf16 v[80:83], v[32:35], v[108:111], v[80:83]
ds_read_b64_tr_b16 v[50:51], v174 offset:45824
v_mfma_f32_16x16x32_bf16 v[68:71], v[36:39], v[104:107], v[68:71]
ds_read_b64_tr_b16 v[52:53], v175 offset:45568
v_mfma_f32_16x16x32_bf16 v[84:87], v[36:39], v[108:111], v[84:87]
ds_read_b64_tr_b16 v[54:55], v175 offset:45824
s_waitcnt vmcnt(4) lgkmcnt(0)
s_barrier
v_mfma_f32_16x16x32_bf16 v[56:59], v[40:43], v[112:115], v[56:59]
ds_read_b64_tr_b16 v[24:25], v189 offset:0
v_mfma_f32_16x16x32_bf16 v[72:75], v[40:43], v[116:119], v[72:75]
ds_read_b64_tr_b16 v[26:27], v189 offset:256
v_mfma_f32_16x16x32_bf16 v[60:63], v[44:47], v[112:115], v[60:63]
ds_read_b64_tr_b16 v[28:29], v191 offset:0
v_mfma_f32_16x16x32_bf16 v[76:79], v[44:47], v[116:119], v[76:79]
ds_read_b64_tr_b16 v[30:31], v191 offset:256
v_mfma_f32_16x16x32_bf16 v[64:67], v[48:51], v[112:115], v[64:67]
ds_read_b64_tr_b16 v[32:33], v189 offset:512
v_mfma_f32_16x16x32_bf16 v[80:83], v[48:51], v[116:119], v[80:83]
ds_read_b64_tr_b16 v[34:35], v189 offset:768
v_mfma_f32_16x16x32_bf16 v[68:71], v[52:55], v[112:115], v[68:71]
ds_read_b64_tr_b16 v[36:37], v191 offset:512
v_mfma_f32_16x16x32_bf16 v[84:87], v[52:55], v[116:119], v[84:87]
ds_read_b64_tr_b16 v[38:39], v191 offset:768
s_waitcnt vmcnt(8) lgkmcnt(0)
v_mfma_f32_16x16x32_bf16 v[56:59], v[24:27], v[144:147], v[56:59]
ds_read_b64_tr_b16 v[40:41], v189 offset:4096
v_mfma_f32_16x16x32_bf16 v[72:75], v[24:27], v[148:151], v[72:75]
ds_read_b64_tr_b16 v[42:43], v189 offset:4352
v_mfma_f32_16x16x32_bf16 v[60:63], v[28:31], v[144:147], v[60:63]
ds_read_b64_tr_b16 v[44:45], v191 offset:4096
v_mfma_f32_16x16x32_bf16 v[76:79], v[28:31], v[148:151], v[76:79]
ds_read_b64_tr_b16 v[46:47], v191 offset:4352
v_mfma_f32_16x16x32_bf16 v[64:67], v[32:35], v[144:147], v[64:67]
ds_read_b64_tr_b16 v[48:49], v189 offset:4608
v_mfma_f32_16x16x32_bf16 v[80:83], v[32:35], v[148:151], v[80:83]
ds_read_b64_tr_b16 v[50:51], v189 offset:4864
v_mfma_f32_16x16x32_bf16 v[68:71], v[36:39], v[144:147], v[68:71]
ds_read_b64_tr_b16 v[52:53], v191 offset:4608
v_mfma_f32_16x16x32_bf16 v[84:87], v[36:39], v[148:151], v[84:87]
ds_read_b64_tr_b16 v[54:55], v191 offset:4864
s_waitcnt vmcnt(5) lgkmcnt(0)
v_mfma_f32_16x16x32_bf16 v[56:59], v[40:43], v[152:155], v[56:59]
ds_read_b64_tr_b16 v[24:25], v189 offset:8192
v_mfma_f32_16x16x32_bf16 v[72:75], v[40:43], v[156:159], v[72:75]
ds_read_b64_tr_b16 v[26:27], v189 offset:8448
v_mfma_f32_16x16x32_bf16 v[60:63], v[44:47], v[152:155], v[60:63]
ds_read_b64_tr_b16 v[28:29], v191 offset:8192
v_mfma_f32_16x16x32_bf16 v[76:79], v[44:47], v[156:159], v[76:79]
ds_read_b64_tr_b16 v[30:31], v191 offset:8448
v_mfma_f32_16x16x32_bf16 v[64:67], v[48:51], v[152:155], v[64:67]
ds_read_b64_tr_b16 v[32:33], v189 offset:8704
v_mfma_f32_16x16x32_bf16 v[80:83], v[48:51], v[156:159], v[80:83]
ds_read_b64_tr_b16 v[34:35], v189 offset:8960
v_mfma_f32_16x16x32_bf16 v[68:71], v[52:55], v[152:155], v[68:71]
ds_read_b64_tr_b16 v[36:37], v191 offset:8704
v_mfma_f32_16x16x32_bf16 v[84:87], v[52:55], v[156:159], v[84:87]
ds_read_b64_tr_b16 v[38:39], v191 offset:8960
s_waitcnt vmcnt(2) lgkmcnt(0)
v_mfma_f32_16x16x32_bf16 v[56:59], v[24:27], v[128:131], v[56:59]
ds_read_b64_tr_b16 v[40:41], v189 offset:12288
v_mfma_f32_16x16x32_bf16 v[72:75], v[24:27], v[132:135], v[72:75]
ds_read_b64_tr_b16 v[42:43], v189 offset:12544
v_mfma_f32_16x16x32_bf16 v[60:63], v[28:31], v[128:131], v[60:63]
ds_read_b64_tr_b16 v[44:45], v191 offset:12288
v_mfma_f32_16x16x32_bf16 v[76:79], v[28:31], v[132:135], v[76:79]
ds_read_b64_tr_b16 v[46:47], v191 offset:12544
v_mfma_f32_16x16x32_bf16 v[64:67], v[32:35], v[128:131], v[64:67]
ds_read_b64_tr_b16 v[48:49], v189 offset:12800
v_mfma_f32_16x16x32_bf16 v[80:83], v[32:35], v[132:135], v[80:83]
ds_read_b64_tr_b16 v[50:51], v189 offset:13056
v_mfma_f32_16x16x32_bf16 v[68:71], v[36:39], v[128:131], v[68:71]
ds_read_b64_tr_b16 v[52:53], v191 offset:12800
v_mfma_f32_16x16x32_bf16 v[84:87], v[36:39], v[132:135], v[84:87]
ds_read_b64_tr_b16 v[54:55], v191 offset:13056
s_waitcnt vmcnt(0) lgkmcnt(0)
v_mfma_f32_16x16x32_bf16 v[56:59], v[40:43], v[136:139], v[56:59]
v_mfma_f32_16x16x32_bf16 v[72:75], v[40:43], v[140:143], v[72:75]
v_mfma_f32_16x16x32_bf16 v[60:63], v[44:47], v[136:139], v[60:63]
v_mfma_f32_16x16x32_bf16 v[76:79], v[44:47], v[140:143], v[76:79]
v_mfma_f32_16x16x32_bf16 v[64:67], v[48:51], v[136:139], v[64:67]
v_mfma_f32_16x16x32_bf16 v[80:83], v[48:51], v[140:143], v[80:83]
v_mfma_f32_16x16x32_bf16 v[68:71], v[52:55], v[136:139], v[68:71]
v_mfma_f32_16x16x32_bf16 v[84:87], v[52:55], v[140:143], v[84:87]
s_lshl_b32 s34, s20, 12
v_add_u32 v5, s34, v1
s_xor_b32 s34, s34, 16384
v_add_u32 v6, s34, v1
s_cmp_eq_u32 s23, 0
s_cbranch_scc0 K3_g1
s_nop 2
ds_write_b128 v5, v[72:75] offset:0
ds_write_b128 v5, v[76:79] offset:1024
ds_write_b128 v5, v[80:83] offset:2048
ds_write_b128 v5, v[84:87] offset:3072
s_branch K3_gj
K3_g1:
s_nop 2
ds_write_b128 v5, v[56:59] offset:0
ds_write_b128 v5, v[60:63] offset:1024
ds_write_b128 v5, v[64:67] offset:2048
ds_write_b128 v5, v[68:71] offset:3072
s_waitcnt lgkmcnt(0)
v_mov_b32 v56, v72
v_mov_b32 v57, v73
v_mov_b32 v58, v74
v_mov_b32 v59, v75
v_mov_b32 v60, v76
v_mov_b32 v61, v77
v_mov_b32 v62, v78
v_mov_b32 v63, v79
v_mov_b32 v64, v80
v_mov_b32 v65, v81
v_mov_b32 v66, v82
v_mov_b32 v67, v83
v_mov_b32 v68, v84
v_mov_b32 v69, v85
v_mov_b32 v70, v86
v_mov_b32 v71, v87
K3_gj:
s_waitcnt lgkmcnt(0)
s_barrier
ds_read_b128 v[88:91], v6 offset:0
ds_read_b128 v[92:95], v6 offset:1024
ds_read_b128 v[96:99], v6 offset:2048
ds_read_b128 v[100:103], v6 offset:3072
s_lshl_b32 s34, s62, 7
s_lshl_b32 s35, s65, 5
s_add_u32 s34, s34, s35
s_lshl_b32 s35, s23, 4
s_add_u32 s34, s34, s35
s_lshl_b32 s34, s34, 11
s_lshl_b32 s35, s63, 7
s_add_u32 s34, s34, s35
v_and_b32 v7, 15, v0
v_lshrrev_b32 v4, 5, v0
v_xor_b32 v4, v4, v7
v_and_b32 v4, 7, v4
v_lshlrev_b32 v4, 4, v4
v_lshl_add_u32 v4, v7, 7, v4
v_bfe_u32 v8, v0, 4, 1
v_lshl_add_u32 v4, v8, 3, v4
s_lshl_b32 s35, s20, 11
s_add_u32 s35, s35, 32768
v_add_u32 v8, s35, v4
v_xor_b32 v9, 32, v8
v_xor_b32 v10, 64, v8
v_xor_b32 v11, 96, v8
v_add_u32 v12, s35, v1
v_lshrrev_b32 v4, 3, v0
v_xor_b32 v7, v4, v0
v_and_b32 v7, 7, v7
v_lshlrev_b32 v7, 4, v7
v_lshl_add_u32 v7, v4, 11, v7
s_add_u32 s35, s34, 16384
s_waitcnt lgkmcnt(3)
v_pk_add_f32 v[56:57], v[56:57], v[88:89]
v_pk_add_f32 v[58:59], v[58:59], v[90:91]
v_cvt_pk_bf16_f32 v104, v56, v57
v_cvt_pk_bf16_f32 v105, v58, v59
ds_write_b64 v8, v[104:105]
s_waitcnt lgkmcnt(3)
v_pk_add_f32 v[60:61], v[60:61], v[92:93]
v_pk_add_f32 v[62:63], v[62:63], v[94:95]
v_cvt_pk_bf16_f32 v106, v60, v61
v_cvt_pk_bf16_f32 v107, v62, v63
ds_write_b64 v9, v[106:107]
s_waitcnt lgkmcnt(3)
v_pk_add_f32 v[64:65], v[64:65], v[96:97]
v_pk_add_f32 v[66:67], v[66:67], v[98:99]
v_cvt_pk_bf16_f32 v108, v64, v65
v_cvt_pk_bf16_f32 v109, v66, v67
ds_write_b64 v10, v[108:109]
s_waitcnt lgkmcnt(3)
v_pk_add_f32 v[68:69], v[68:69], v[100:101]
v_pk_add_f32 v[70:71], v[70:71], v[102:103]
v_cvt_pk_bf16_f32 v110, v68, v69
v_cvt_pk_bf16_f32 v111, v70, v71
ds_write_b64 v11, v[110:111]
s_waitcnt lgkmcnt(0)
ds_read_b128 v[88:91], v12
ds_read_b128 v[92:95], v12 offset:1024
s_waitcnt lgkmcnt(1)
buffer_store_dwordx4 v[88:91], v7, s[16:19], s34 offen nt
s_waitcnt lgkmcnt(0)
buffer_store_dwordx4 v[92:95], v7, s[16:19], s35 offen nt
s_endpgm
K2_spinA:
s_mov_b32 s56, 0
K2_spinA_l:
buffer_load_dword v178, v179, s[12:15], s33 offen sc1
s_add_u32 s56, s56, 1
s_waitcnt vmcnt(0)
v_cmp_ne_u32 vcc, 1, v178
s_cmp_ge_u32 s56, 4000
s_cbranch_scc1 K2_spinA_b
s_nop 1
s_cbranch_vccnz K2_spinA_l
s_branch K2_spinA_b
K3_spinB:
s_add_u32 s35, s33, 1024
s_mov_b32 s56, 0
K3_spinB_l:
buffer_load_dword v178, v179, s[12:15], s35 offen sc1
s_add_u32 s56, s56, 1
s_waitcnt vmcnt(0)
v_cmp_ne_u32 vcc, 1, v178
s_cmp_ge_u32 s56, 4000
s_cbranch_scc1 K3_spinB_b
s_nop 1
s_cbranch_vccnz K3_spinB_l
s_branch K3_spinB_b
K1_spinR:
s_mov_b32 s56, 0
K1_spinR_l:
buffer_load_dword v239, off, s[52:55], 0 sc1
s_add_u32 s56, s56, 1
s_waitcnt vmcnt(0)
v_cmp_ne_u32 vcc, 1, v239
s_cmp_ge_u32 s56, 4000
s_cbranch_scc1 K1_spinR_b
s_nop 1
s_cbranch_vccnz K1_spinR_l
s_branch K1_spinR_b
K2_spinP1:
s_mov_b32 s56, 0
K2_spinP1_l:
buffer_load_dword v178, off, s[12:15], s101 sc1
s_add_u32 s56, s56, 1
s_waitcnt vmcnt(0)
v_cmp_ne_u32 vcc, 1, v178
s_cmp_ge_u32 s56, 4000
s_cbranch_scc1 K2_spinP1_b
s_nop 1
s_cbranch_vccnz K2_spinP1_l
s_branch K2_spinP1_b
K2_spinP2:
s_mov_b32 s56, 0
K2_spinP2_l:
buffer_load_dword v178, off, s[12:15], s64 sc1
s_add_u32 s56, s56, 1
s_waitcnt vmcnt(0)
v_cmp_ne_u32 vcc, 1, v178
s_cmp_ge_u32 s56, 4000
s_cbranch_scc1 K2_spinP2_b
s_nop 1
s_cbranch_vccnz K2_spinP2_l
s_branch K2_spinP2_b
K2_spinA1:
s_mov_b32 s56, 0
K2_spinA1_l:
buffer_load_dword v178, v188, s[12:15], 0 offen sc1
s_add_u32 s56, s56, 1
s_waitcnt vmcnt(0)
v_cmp_ne_u32 vcc, 1, v178
s_cmp_ge_u32 s56, 4000
s_cbranch_scc1 K2_spinA1_b
s_nop 1
s_cbranch_vccnz K2_spinA1_l
s_branch K2_spinA1_b
K2_fallback:
s_cmp_eq_u32 s23, 0
s_cbranch_scc1 K2_fbq
v_mov_b32 v8, v16
v_mov_b32 v9, v17
v_mov_b32 v10, v18
v_mov_b32 v11, v19
v_mov_b32 v12, v20
v_mov_b32 v13, v21
v_mov_b32 v14, v22
v_mov_b32 v15, v23
K2_fbq:
s_lshl_b32 s24, s22, 18
s_mov_b32 s27, 64
v_mov_b32 v4, 0xff800000
K2_fbl:
buffer_load_dwordx4 v[56:59], v1, s[12:15], s24 offen sc1
buffer_load_dwordx4 v[60:63], v1, s[12:15], s24 offen offset:1024 sc1
s_waitcnt vmcnt(0)
v_mfma_f32_32x32x16_bf16 v[40:55], v[56:59], v[8:11], 0
v_mfma_f32_32x32x16_bf16 v[40:55], v[60:63], v[12:15], v[40:55]
s_nop 7
s_nop 3
v_max3_f32 v4, v4, v40, v41
v_max3_f32 v4, v4, v42, v43
v_max3_f32 v4, v4, v44, v45
v_max3_f32 v4, v4, v46, v47
v_max3_f32 v4, v4, v48, v49
v_max3_f32 v4, v4, v50, v51
v_max3_f32 v4, v4, v52, v53
v_max3_f32 v4, v4, v54, v55
s_add_u32 s24, s24, 4096
s_sub_u32 s27, s27, 1
s_cmp_lg_u32 s27, 0
s_cbranch_scc1 K2_fbl
v_mov_b32 v5, v4
s_nop 1
v_permlane32_swap_b32 v4, v5
v_max_f32 v4, v4, v5
v_sub_f32 v24, 0, v4
v_mov_b32 v128, 0
v_sub_f32 v25, 0, v4
v_mov_b32 v129, 0
v_sub_f32 v26, 0, v4
v_mov_b32 v130, 0
v_sub_f32 v27, 0, v4
v_mov_b32 v131, 0
v_sub_f32 v28, 0, v4
v_mov_b32 v132, 0
v_sub_f32 v29, 0, v4
v_mov_b32 v133, 0
v_sub_f32 v30, 0, v4
v_mov_b32 v134, 0
v_sub_f32 v31, 0, v4
v_mov_b32 v135, 0
v_sub_f32 v32, 0, v4
v_mov_b32 v136, 0
v_sub_f32 v33, 0, v4
v_mov_b32 v137, 0
v_sub_f32 v34, 0, v4
v_mov_b32 v138, 0
v_sub_f32 v35, 0, v4
v_mov_b32 v139, 0
v_sub_f32 v36, 0, v4
v_mov_b32 v140, 0
v_sub_f32 v37, 0, v4
v_mov_b32 v141, 0
v_sub_f32 v38, 0, v4
v_mov_b32 v142, 0
v_sub_f32 v39, 0, v4
v_mov_b32 v143, 0
v_mov_b32 v160, 0
v_mov_b32 v161, 0
v_mov_b32 v162, 0
v_mov_b32 v163, 0
s_lshl_b32 s24, s22, 18
s_mov_b32 s27, 64
K2_fb2:
buffer_load_dwordx4 v[56:59], v1, s[12:15], s24 offen sc1
buffer_load_dwordx4 v[60:63], v1, s[12:15], s24 offen offset:1024 sc1
buffer_load_dwordx4 v[72:75], v1, s[12:15], s24 offen offset:2048 sc1
buffer_load_dwordx4 v[76:79], v1, s[12:15], s24 offen offset:3072 sc1
s_waitcnt vmcnt(0)
v_mfma_f32_32x32x16_bf16 v[40:55], v[56:59], v[8:11], v[24:39]
v_mfma_f32_32x32x16_bf16 v[40:55], v[60:63], v[12:15], v[40:55]
s_nop 7
s_nop 3
v_exp_f32 v40, v40
v_exp_f32 v41, v41
v_exp_f32 v42, v42
v_exp_f32 v43, v43
v_exp_f32 v44, v44
v_exp_f32 v45, v45
v_exp_f32 v46, v46
v_exp_f32 v47, v47
v_exp_f32 v48, v48
v_exp_f32 v49, v49
v_exp_f32 v50, v50
v_exp_f32 v51, v51
v_exp_f32 v52, v52
v_exp_f32 v53, v53
v_exp_f32 v54, v54
v_exp_f32 v55, v55
s_nop 0
s_nop 1
v_smfmac_f32_32x32x32_bf16 v[128:143], v[72:75], v[40:47], v189
v_smfmac_f32_16x16x64_bf16 v[160:163], v[168:171], v[40:47], v189
v_smfmac_f32_32x32x32_bf16 v[128:143], v[76:79], v[48:55], v189
v_smfmac_f32_16x16x64_bf16 v[160:163], v[168:171], v[48:55], v189
s_add_u32 s24, s24, 4096
s_sub_u32 s27, s27, 1
s_cmp_lg_u32 s27, 0
s_cbranch_scc1 K2_fb2
s_nop 7
s_nop 7
s_branch K2_fin
K2_end:
s_endpgm
.section .rodata,"a"
.p2align 6
.amdhsa_kernel gated_mix__linear_kernel_hedgehog__softmax_full_mha__prompt_kernel
  .amdhsa_next_free_vgpr 256
  .amdhsa_next_free_sgpr 102
  .amdhsa_accum_offset 256
  .amdhsa_group_segment_fixed_size 0
  .amdhsa_kernarg_size 88
  .amdhsa_user_sgpr_count 2
  .amdhsa_user_sgpr_kernarg_segment_ptr 1
  .amdhsa_system_sgpr_workgroup_id_x 1
  .amdhsa_float_denorm_mode_32 3
.end_amdhsa_kernel
```
